```python
import torch

def _softmax(x, axis=-1):
    return torch.softmax(x, dim=axis)
def _gelu(x):
    return torch.nn.functional.gelu(x, approximate="tanh")
def _silu(x):
    return torch.nn.functional.silu(x)
def _sigmoid(x):
    return torch.sigmoid(x)
def _layernorm(x, axis=-1, eps=1e-5):
    m = x.mean(dim=axis, keepdim=True)
    v = x.var(dim=axis, keepdim=True, unbiased=False)
    return (x - m) / torch.sqrt(v + eps)
def _scatter_add(tgt, idx, src, axis=0):
    return tgt.clone().index_add_(axis, idx, src)
def _segment_sum(src, seg, n):
    out = torch.zeros((n,) + src.shape[1:], dtype=src.dtype)
    return out.index_add_(0, seg, src)
def _pad(x, pw):
    flat = tuple(v for pair in reversed(pw) for v in pair)
    return torch.nn.functional.pad(x, flat)

kernel_name = 'standalone__deep_cross_wide_deep__recsys'

def setup_inputs():

    _w = (lambda a: (lambda t: t.to(torch.bfloat16) if t.is_floating_point() else t)(torch.as_tensor(a)))
    B, F, D = 16384, 100, 32
    V, Nd = min(1000, 100000), 13
    Din = F * D
    H = 4 * D
    return {
        "idx": _w((lambda lo, hi, *s: torch.randint(lo, hi, s))(0, V, B, F).to(torch.int64)),
        "table": _w((lambda *s: torch.randn(*s, dtype=torch.bfloat16) * 1.6)(V, D) * 0.05),
        "x_wide": _w((lambda *s: torch.randn(*s, dtype=torch.bfloat16) * 1.6)(B, Nd)),
        "w_wide": _w((lambda *s: torch.randn(*s, dtype=torch.bfloat16) * 1.6)(Nd) * 0.05),
        "b_wide": _w((lambda *s: torch.randn(*s, dtype=torch.bfloat16) * 1.6)(1) * 0.01),
        "W1": _w((lambda *s: torch.randn(*s, dtype=torch.bfloat16) * 1.6)(Din, H) * (2.0 / Din) ** 0.5),
        "b1": _w((lambda *s: torch.randn(*s, dtype=torch.bfloat16) * 1.6)(H) * 0.01),
        "W2": _w((lambda *s: torch.randn(*s, dtype=torch.bfloat16) * 1.6)(H) * (1.0 / H) ** 0.5),
        "b2": _w((lambda *s: torch.randn(*s, dtype=torch.bfloat16) * 1.6)(1) * 0.01),
    }

def reference(idx, table, x_wide, w_wide, b_wide, W1, b1, W2, b2):
    emb = table[idx]
    deep_in = emb.reshape(emb.shape[0], -1)
    h = deep_in @ W1 + b1
    h = h * (lambda x, dt: x.to(dt))(h > 0, h.dtype)
    deep_logit = h @ W2 + b2
    wide_logit = x_wide @ w_wide + b_wide
    return _sigmoid(wide_logit + deep_logit)
```

```asm
; @launch grid=(256,1,1) block=(256,1,1) lds=163200
.amdgcn_target "amdgcn-amd-amdhsa--gfx950"
.text
.globl standalone__deep_cross_wide_deep__recsys_kernel
.p2align 8
.type standalone__deep_cross_wide_deep__recsys_kernel,@function
standalone__deep_cross_wide_deep__recsys_kernel:
    s_cmp_ge_u32 s2, 256
    s_cbranch_scc1 L_end
    s_load_dwordx2 s[36:37], s[0:1], 0
    s_load_dwordx2 s[40:41], s[0:1], 8
    s_load_dwordx2 s[44:45], s[0:1], 40
    s_load_dwordx16 s[16:31], s[0:1], 0
    s_load_dwordx8 s[64:71], s[0:1], 64
    v_lshrrev_b32 v2, 6, v0
    v_and_b32 v1, 63, v0
    v_readfirstlane_b32 s3, v2
    v_lshlrev_b32 v7, 4, v1
    s_lshr_b32 s6, s2, 3
    s_getpc_b64 s[32:33]
L_pc:
    s_mov_b32 s34, L_end-L_pc
    s_mov_b32 s35, 0x20000
    v_lshlrev_b32 v61, 7, v0
    s_cmp_lt_u32 s6, 2
    s_cbranch_scc0 L_noct
    buffer_load_dword v62, v61, s[32:35], 0 offen
L_noct:
    s_mul_i32 s11, s2, 25600
    s_mul_i32 m0, s3, 6400
    s_mov_b32 s38, 6553600
    s_mov_b32 s39, 0x20000
    s_add_u32 s97, s11, m0
    s_mov_b32 s42, 64000
    s_mov_b32 s43, 0x20000
    s_add_u32 s93, s6, s3
    s_lshl_b32 s93, s93, 12
    s_waitcnt lgkmcnt(0)
    buffer_load_dwordx4 v7, s[36:39], s97 offen offset:0 lds
    buffer_load_dwordx4 v7, s[36:39], s97 offen offset:1024 lds
    buffer_load_dwordx4 v7, s[36:39], s97 offen offset:2048 lds
    buffer_load_dwordx4 v7, s[36:39], s97 offen offset:3072 lds
    s_mul_i32 m0, s3, 6400
    s_add_u32 m0, m0, 4096
    s_add_u32 s97, s97, 4096
    buffer_load_dwordx4 v7, s[36:39], s97 offen offset:0 lds
    buffer_load_dwordx4 v7, s[36:39], s97 offen offset:1024 lds
    buffer_load_dwordx4 v7, s[36:39], s97 offen offset:2048 lds
    s_and_b32 s93, s93, 0xffff
    buffer_load_dwordx4 a[160:163], v7, s[40:43], s93 offen offset:0
    buffer_load_dwordx4 a[164:167], v7, s[40:43], s93 offen offset:1024
    buffer_load_dwordx4 a[168:171], v7, s[40:43], s93 offen offset:2048
    buffer_load_dwordx4 a[172:175], v7, s[40:43], s93 offen offset:3072
    s_add_u32 s94, s93, 0x4000
    s_and_b32 s94, s94, 0xffff
    buffer_load_dwordx4 a[176:179], v7, s[40:43], s94 offen offset:0
    buffer_load_dwordx4 a[180:183], v7, s[40:43], s94 offen offset:1024
    buffer_load_dwordx4 a[184:187], v7, s[40:43], s94 offen offset:2048
    buffer_load_dwordx4 a[188:191], v7, s[40:43], s94 offen offset:3072
    s_add_u32 s95, s94, 0x4000
    s_load_dwordx8 s[72:79], s[22:23], 0
    s_load_dword s80, s[24:25], 0
    s_load_dword s81, s[64:65], 0
    s_mov_b32 s46, 819200
    s_mov_b32 s47, 0x20000
    s_and_b32 s9, s6, 31
    s_lshl_b32 s9, s9, 2
    s_add_u32 s9, s9, s3
    s_lshl_b32 s10, s9, 4
    v_min_u32 v59, 15, v1
    v_add_lshl_u32 v59, v59, s10, 7
    s_lshl_b32 s10, s9, 3
    v_min_u32 v60, 7, v1
    v_add_lshl_u32 v60, v60, s10, 7
    v_and_b32 v3, 15, v0
    v_bfe_u32 v4, v0, 4, 2
    v_lshlrev_b32 v8, 2, v1
    s_mov_b32 s52, s28
    s_and_b32 s53, s29, 0xffff
    s_mov_b32 s54, 256
    s_mov_b32 s55, 0x20000
    s_mov_b32 s56, s30
    s_and_b32 s57, s31, 0xffff
    s_mov_b32 s58, 256
    s_mov_b32 s59, 0x20000
    s_mov_b32 s48, s20
    s_and_b32 s49, s21, 0xffff
    s_mov_b32 s50, 425984
    s_mov_b32 s51, 0x20000
    s_lshl_b32 s10, s2, 6
    v_add_u32 v11, s10, v1
    v_mul_u32_u24 v11, 26, v11
    v_and_b32 v56, 2, v11
    v_lshlrev_b32 v56, 3, v56
    v_and_b32 v11, -4, v11
    v_lshlrev_b32 v5, 11, v4
    v_lshl_add_u32 v5, v3, 4, v5
    s_lshl_b32 s8, s3, 15
    s_and_b32 s92, s6, 1
    s_lshl_b32 s9, s92, 17
    s_sub_u32 s83, s8, s9
    s_add_u32 s8, s8, s9
    s_lshl_b32 s92, s92, 7
    s_lshl_b32 s15, s3, 13
    s_add_u32 s15, s15, 786432
    s_mov_b32 s60, s66
    s_and_b32 s61, s67, 0xffff
    s_mov_b32 s62, 32768
    s_mov_b32 s63, 0x20000
    s_mov_b32 s4, 0x05040100
    s_mov_b32 s5, 0x07060302
    s_mul_i32 s14, s3, 24576
    v_mul_u32_u24 v6, 16032, v4
    v_add_u32 v6, 98304, v6
    v_mul_u32_u24 v12, 400, v3
    s_add_u32 s9, s3, 0
    s_and_b32 s9, s9, 3
    s_mul_i32 s9, s9, 6400
    s_lshl_b32 s10, s3, 4
    s_add_u32 s9, s9, s10
    s_lshr_b32 s10, s92, 1
    s_add_u32 s9, s9, s10
    v_add_u32 v32, s9, v12
    s_add_u32 s9, s3, 1
    s_and_b32 s9, s9, 3
    s_mul_i32 s9, s9, 6400
    s_lshl_b32 s10, s3, 4
    s_add_u32 s9, s9, s10
    s_lshr_b32 s10, s92, 1
    s_add_u32 s9, s9, s10
    v_add_u32 v33, s9, v12
    s_add_u32 s9, s3, 2
    s_and_b32 s9, s9, 3
    s_mul_i32 s9, s9, 6400
    s_lshl_b32 s10, s3, 4
    s_add_u32 s9, s9, s10
    s_lshr_b32 s10, s92, 1
    s_add_u32 s9, s9, s10
    v_add_u32 v34, s9, v12
    s_add_u32 s9, s3, 3
    s_and_b32 s9, s9, 3
    s_mul_i32 s9, s9, 6400
    s_lshl_b32 s10, s3, 4
    s_add_u32 s9, s9, s10
    s_lshr_b32 s10, s92, 1
    s_add_u32 s9, s9, s10
    v_add_u32 v35, s9, v12
    v_add_u32 v44, s14, v7
    s_sub_u32 s10, s3, 1
    s_and_b32 s10, s10, 3
    s_mul_i32 s10, s10, 24576
    v_add_u32 v45, s10, v7
    s_sub_u32 s10, s3, 2
    s_and_b32 s10, s10, 3
    s_mul_i32 s10, s10, 24576
    v_add_u32 v46, s10, v7
    s_sub_u32 s10, s3, 3
    s_and_b32 s10, s10, 3
    s_mul_i32 s10, s10, 24576
    v_add_u32 v47, s10, v7
    s_lshl_b32 s10, s2, 7
    s_lshl_b32 s12, s3, 5
    s_add_u32 s10, s10, s12
    v_lshl_add_u32 v63, v3, 1, s10
    v_and_b32 v13, 3, v0
    v_mul_u32_u24 v13, 16032, v13
    v_add_u32 v13, 98304, v13
    v_lshrrev_b32 v14, 2, v1
    s_and_b32 s95, s95, 0xffff
    buffer_load_dwordx4 a[192:195], v7, s[40:43], s95 offen offset:0
    buffer_load_dwordx4 a[196:199], v7, s[40:43], s95 offen offset:1024
    buffer_load_dwordx4 a[200:203], v7, s[40:43], s95 offen offset:2048
    buffer_load_dwordx4 a[204:207], v7, s[40:43], s95 offen offset:3072
    s_add_u32 s96, s95, 0x4000
    s_and_b32 s96, s96, 0xffff
    buffer_load_dwordx4 a[208:211], v7, s[40:43], s96 offen offset:0
    buffer_load_dwordx4 a[212:215], v7, s[40:43], s96 offen offset:1024
    buffer_load_dwordx4 a[216:219], v7, s[40:43], s96 offen offset:2048
    buffer_load_dwordx4 a[220:223], v7, s[40:43], s96 offen offset:3072
    buffer_load_dword v62, v59, s[44:47], 0 offen
    s_cmp_lt_u32 s3, 2
    s_cbranch_scc1 L_spdone
    s_cmp_eq_u32 s3, 3
    s_cbranch_scc1 L_sp3
    s_mov_b32 m0, 162432
    s_nop 0
    buffer_load_dword v8, s[52:55], 0 offen lds
    s_mov_b32 m0, 162688
    s_nop 0
    buffer_load_dword v8, s[56:59], 0 offen lds
    s_branch L_spdone
L_sp3:
    buffer_load_dwordx4 v[48:51], v11, s[48:51], 0 offen
    buffer_load_dwordx4 v[52:55], v11, s[48:51], 0 offen offset:16
L_spdone:
    s_add_u32 s7, s8, 0
    buffer_load_dwordx4 v[96:99], v5, s[44:47], s7 offen offset:0
    buffer_load_dwordx4 v[100:103], v5, s[44:47], s7 offen offset:256
    buffer_load_dwordx4 v[104:107], v5, s[44:47], s7 offen offset:512
    buffer_load_dwordx4 v[108:111], v5, s[44:47], s7 offen offset:768
    buffer_load_dwordx4 v[112:115], v5, s[44:47], s7 offen offset:1024
    buffer_load_dwordx4 v[116:119], v5, s[44:47], s7 offen offset:1280
    buffer_load_dwordx4 v[120:123], v5, s[44:47], s7 offen offset:1536
    buffer_load_dwordx4 v[124:127], v5, s[44:47], s7 offen offset:1792
    s_waitcnt lgkmcnt(0)
    s_lshr_b32 s12, s93, 6
    v_add_u32 v12, s12, v14
    v_lshl_add_u32 v2, v12, 4, v13
    s_waitcnt vmcnt(24)
    ds_write_b128 v2, a[160:163]
    s_waitcnt vmcnt(23)
    ds_write_b128 v2, a[164:167] offset:256
    v_add_u32 v2, 32, v12
    v_min_u32 v2, 1000, v2
    v_lshl_add_u32 v2, v2, 4, v13
    s_waitcnt vmcnt(22)
    ds_write_b128 v2, a[168:171]
    v_add_u32 v2, 48, v12
    v_min_u32 v2, 1000, v2
    v_lshl_add_u32 v2, v2, 4, v13
    s_waitcnt vmcnt(21)
    ds_write_b128 v2, a[172:175]
    s_lshr_b32 s12, s94, 6
    v_add_u32 v12, s12, v14
    v_lshl_add_u32 v2, v12, 4, v13
    s_waitcnt vmcnt(20)
    ds_write_b128 v2, a[176:179]
    s_waitcnt vmcnt(19)
    ds_write_b128 v2, a[180:183] offset:256
    v_add_u32 v2, 32, v12
    v_min_u32 v2, 1000, v2
    v_lshl_add_u32 v2, v2, 4, v13
    s_waitcnt vmcnt(18)
    ds_write_b128 v2, a[184:187]
    v_add_u32 v2, 48, v12
    v_min_u32 v2, 1000, v2
    v_lshl_add_u32 v2, v2, 4, v13
    s_waitcnt vmcnt(17)
    ds_write_b128 v2, a[188:191]
    s_lshr_b32 s12, s95, 6
    v_add_u32 v12, s12, v14
    v_lshl_add_u32 v2, v12, 4, v13
    s_waitcnt vmcnt(16)
    ds_write_b128 v2, a[192:195]
    s_waitcnt vmcnt(15)
    ds_write_b128 v2, a[196:199] offset:256
    v_add_u32 v2, 32, v12
    v_min_u32 v2, 1000, v2
    v_lshl_add_u32 v2, v2, 4, v13
    s_waitcnt vmcnt(14)
    ds_write_b128 v2, a[200:203]
    v_add_u32 v2, 48, v12
    v_min_u32 v2, 1000, v2
    v_lshl_add_u32 v2, v2, 4, v13
    s_waitcnt vmcnt(13)
    ds_write_b128 v2, a[204:207]
    s_lshr_b32 s12, s96, 6
    v_add_u32 v12, s12, v14
    v_lshl_add_u32 v2, v12, 4, v13
    s_waitcnt vmcnt(12)
    ds_write_b128 v2, a[208:211]
    s_add_u32 s7, s8, 8192
    buffer_load_dwordx4 v[128:131], v5, s[44:47], s7 offen offset:0
    s_waitcnt vmcnt(12)
    ds_write_b128 v2, a[212:215] offset:256
    buffer_load_dwordx4 v[132:135], v5, s[44:47], s7 offen offset:256
    v_add_u32 v2, 32, v12
    v_min_u32 v2, 1000, v2
    v_lshl_add_u32 v2, v2, 4, v13
    s_waitcnt vmcnt(12)
    ds_write_b128 v2, a[216:219]
    buffer_load_dwordx4 v[136:139], v5, s[44:47], s7 offen offset:512
    v_add_u32 v2, 48, v12
    v_min_u32 v2, 1000, v2
    v_lshl_add_u32 v2, v2, 4, v13
    s_waitcnt vmcnt(12)
    ds_write_b128 v2, a[220:223]
    buffer_load_dwordx4 v[140:143], v5, s[44:47], s7 offen offset:768
    buffer_load_dwordx4 v[144:147], v5, s[44:47], s7 offen offset:1024
    buffer_load_dwordx4 v[148:151], v5, s[44:47], s7 offen offset:1280
    buffer_load_dwordx4 v[152:155], v5, s[44:47], s7 offen offset:1536
    buffer_load_dwordx4 v[156:159], v5, s[44:47], s7 offen offset:1792
    s_waitcnt lgkmcnt(0)
    s_barrier
    ds_read_b128 v[16:19], v32 offset:0
    ds_read_b128 v[20:23], v33 offset:0
    ds_read_b128 v[24:27], v34 offset:0
    ds_read_b128 v[28:31], v35 offset:0
    s_add_u32 s7, s8, 16384
    buffer_load_dwordx4 v[160:163], v5, s[44:47], s7 offen offset:0
    buffer_load_dwordx4 v[164:167], v5, s[44:47], s7 offen offset:256
    buffer_load_dwordx4 v[168:171], v5, s[44:47], s7 offen offset:512
    buffer_load_dwordx4 v[172:175], v5, s[44:47], s7 offen offset:768
    s_waitcnt vmcnt(12)
    v_perm_b32 v64, v100, v96, s4
    v_perm_b32 v65, v108, v104, s4
    v_perm_b32 v66, v116, v112, s4
    v_perm_b32 v67, v124, v120, s4
    v_perm_b32 v68, v100, v96, s5
    v_perm_b32 v69, v108, v104, s5
    v_perm_b32 v70, v116, v112, s5
    v_perm_b32 v71, v124, v120, s5
    v_perm_b32 v72, v101, v97, s4
    v_perm_b32 v73, v109, v105, s4
    v_perm_b32 v74, v117, v113, s4
    v_perm_b32 v75, v125, v121, s4
    s_waitcnt lgkmcnt(3)
    v_lshl_add_u32 v16, v16, 4, v6
    ds_read_b128 a[128:131], v16
    s_waitcnt lgkmcnt(3)
    v_lshl_add_u32 v20, v20, 4, v6
    ds_read_b128 a[132:135], v20
    s_waitcnt lgkmcnt(3)
    v_lshl_add_u32 v24, v24, 4, v6
    ds_read_b128 a[136:139], v24
    s_waitcnt lgkmcnt(3)
    v_lshl_add_u32 v28, v28, 4, v6
    ds_read_b128 a[140:143], v28
    v_lshl_add_u32 v17, v17, 4, v6
    v_lshl_add_u32 v18, v18, 4, v6
    v_lshl_add_u32 v19, v19, 4, v6
    v_subrev_u32 v32, s92, v32
    v_lshl_add_u32 v21, v21, 4, v6
    v_lshl_add_u32 v22, v22, 4, v6
    v_lshl_add_u32 v23, v23, 4, v6
    v_subrev_u32 v33, s92, v33
    v_lshl_add_u32 v25, v25, 4, v6
    v_lshl_add_u32 v26, v26, 4, v6
    v_lshl_add_u32 v27, v27, 4, v6
    v_subrev_u32 v34, s92, v34
    v_lshl_add_u32 v29, v29, 4, v6
    v_lshl_add_u32 v30, v30, 4, v6
    v_lshl_add_u32 v31, v31, 4, v6
    v_subrev_u32 v35, s92, v35
    v_perm_b32 v76, v101, v97, s5
    v_perm_b32 v77, v109, v105, s5
    v_perm_b32 v78, v117, v113, s5
    v_perm_b32 v79, v125, v121, s5
    v_perm_b32 v80, v102, v98, s4
    v_perm_b32 v81, v110, v106, s4
    v_perm_b32 v82, v118, v114, s4
    v_perm_b32 v83, v126, v122, s4
    v_perm_b32 v84, v102, v98, s5
    v_perm_b32 v85, v110, v106, s5
    v_perm_b32 v86, v118, v114, s5
    v_perm_b32 v87, v126, v122, s5
    v_perm_b32 v88, v103, v99, s4
    v_perm_b32 v89, v111, v107, s4
    v_perm_b32 v90, v119, v115, s4
    v_perm_b32 v91, v127, v123, s4
    s_waitcnt lgkmcnt(3)
    v_mfma_f32_16x16x32_bf16 a[0:3], v[64:67], a[128:131], 0
    v_perm_b32 v92, v103, v99, s5
    s_waitcnt lgkmcnt(2)
    v_mfma_f32_16x16x32_bf16 a[4:7], v[64:67], a[132:135], 0
    buffer_load_dwordx4 v[176:179], v5, s[44:47], s7 offen offset:1024
    v_perm_b32 v93, v111, v107, s5
    s_waitcnt lgkmcnt(1)
    v_mfma_f32_16x16x32_bf16 a[8:11], v[64:67], a[136:139], 0
    ds_read_b128 a[144:147], v17
    v_perm_b32 v94, v119, v115, s5
    s_waitcnt lgkmcnt(1)
    v_mfma_f32_16x16x32_bf16 a[12:15], v[64:67], a[140:143], 0
    v_perm_b32 v95, v127, v123, s5
    s_waitcnt vmcnt(5)
    v_mfma_f32_16x16x32_bf16 a[28:31], v[68:71], a[140:143], 0
    buffer_load_dwordx4 v[180:183], v5, s[44:47], s7 offen offset:1280
    v_mfma_f32_16x16x32_bf16 a[24:27], v[68:71], a[136:139], 0
    v_perm_b32 v64, v132, v128, s4
    v_perm_b32 v65, v140, v136, s4
    v_mfma_f32_16x16x32_bf16 a[20:23], v[68:71], a[132:135], 0
    v_perm_b32 v66, v148, v144, s4
    v_mfma_f32_16x16x32_bf16 a[16:19], v[68:71], a[128:131], 0
    buffer_load_dwordx4 v[184:187], v5, s[44:47], s7 offen offset:1536
    v_perm_b32 v67, v156, v152, s4
    v_mfma_f32_16x16x32_bf16 a[32:35], v[72:75], a[128:131], 0
    ds_read_b128 a[148:151], v21
    v_perm_b32 v68, v132, v128, s5
    v_mfma_f32_16x16x32_bf16 a[36:39], v[72:75], a[132:135], 0
    v_perm_b32 v69, v140, v136, s5
    v_mfma_f32_16x16x32_bf16 a[40:43], v[72:75], a[136:139], 0
    buffer_load_dwordx4 v[188:191], v5, s[44:47], s7 offen offset:1792
    v_mfma_f32_16x16x32_bf16 a[44:47], v[72:75], a[140:143], 0
    v_perm_b32 v70, v148, v144, s5
    v_perm_b32 v71, v156, v152, s5
    v_mfma_f32_16x16x32_bf16 a[60:63], v[76:79], a[140:143], 0
    v_perm_b32 v72, v133, v129, s4
    v_mfma_f32_16x16x32_bf16 a[56:59], v[76:79], a[136:139], 0
    s_add_u32 s7, s8, 24576
    buffer_load_dwordx4 v[192:195], v5, s[44:47], s7 offen offset:0
    v_perm_b32 v73, v141, v137, s4
    v_mfma_f32_16x16x32_bf16 a[52:55], v[76:79], a[132:135], 0
    ds_read_b128 a[152:155], v25
    v_perm_b32 v74, v149, v145, s4
    v_mfma_f32_16x16x32_bf16 a[48:51], v[76:79], a[128:131], 0
    v_perm_b32 v75, v157, v153, s4
    v_mfma_f32_16x16x32_bf16 a[64:67], v[80:83], a[128:131], 0
    buffer_load_dwordx4 v[196:199], v5, s[44:47], s7 offen offset:256
    v_mfma_f32_16x16x32_bf16 a[68:71], v[80:83], a[132:135], 0
    v_perm_b32 v76, v133, v129, s5
    v_perm_b32 v77, v141, v137, s5
    v_mfma_f32_16x16x32_bf16 a[72:75], v[80:83], a[136:139], 0
    v_perm_b32 v78, v149, v145, s5
    v_mfma_f32_16x16x32_bf16 a[76:79], v[80:83], a[140:143], 0
    buffer_load_dwordx4 v[200:203], v5, s[44:47], s7 offen offset:512
    v_perm_b32 v79, v157, v153, s5
    v_mfma_f32_16x16x32_bf16 a[92:95], v[84:87], a[140:143], 0
    ds_read_b128 a[156:159], v29
    v_perm_b32 v80, v134, v130, s4
    v_mfma_f32_16x16x32_bf16 a[88:91], v[84:87], a[136:139], 0
    v_perm_b32 v81, v142, v138, s4
    v_mfma_f32_16x16x32_bf16 a[84:87], v[84:87], a[132:135], 0
    buffer_load_dwordx4 v[204:207], v5, s[44:47], s7 offen offset:768
    v_mfma_f32_16x16x32_bf16 a[80:83], v[84:87], a[128:131], 0
    v_perm_b32 v82, v150, v146, s4
    v_perm_b32 v83, v158, v154, s4
    v_mfma_f32_16x16x32_bf16 a[96:99], v[88:91], a[128:131], 0
    v_perm_b32 v84, v134, v130, s5
    v_mfma_f32_16x16x32_bf16 a[100:103], v[88:91], a[132:135], 0
    buffer_load_dwordx4 v[208:211], v5, s[44:47], s7 offen offset:1024
    v_mfma_f32_16x16x32_bf16 a[104:107], v[88:91], a[136:139], 0
    v_perm_b32 v85, v142, v138, s5
    v_perm_b32 v86, v150, v146, s5
    v_mfma_f32_16x16x32_bf16 a[108:111], v[88:91], a[140:143], 0
    v_perm_b32 v87, v158, v154, s5
    v_mfma_f32_16x16x32_bf16 a[124:127], v[92:95], a[140:143], 0
    buffer_load_dwordx4 v[212:215], v5, s[44:47], s7 offen offset:1280
    v_mfma_f32_16x16x32_bf16 a[120:123], v[92:95], a[136:139], 0
    v_perm_b32 v88, v135, v131, s4
    v_perm_b32 v89, v143, v139, s4
    v_mfma_f32_16x16x32_bf16 a[116:119], v[92:95], a[132:135], 0
    v_perm_b32 v90, v151, v147, s4
    v_mfma_f32_16x16x32_bf16 a[112:115], v[92:95], a[128:131], 0
    s_mov_b32 s12, 262144
    buffer_load_dword v62, v60, s[44:47], s12 offen
    v_perm_b32 v91, v159, v155, s4
    s_waitcnt lgkmcnt(3)
    v_mfma_f32_16x16x32_bf16 a[0:3], v[64:67], a[144:147], a[0:3]
    v_perm_b32 v92, v135, v131, s5
    s_waitcnt lgkmcnt(2)
    v_mfma_f32_16x16x32_bf16 a[4:7], v[64:67], a[148:151], a[4:7]
    v_perm_b32 v93, v143, v139, s5
    s_waitcnt lgkmcnt(1)
    v_mfma_f32_16x16x32_bf16 a[8:11], v[64:67], a[152:155], a[8:11]
    ds_read_b128 a[128:131], v18
    s_mov_b32 s12, 393216
    buffer_load_dword v62, v60, s[44:47], s12 offen
    s_waitcnt lgkmcnt(1)
    v_mfma_f32_16x16x32_bf16 a[12:15], v[64:67], a[156:159], a[12:15]
    v_perm_b32 v94, v151, v147, s5
    v_perm_b32 v95, v159, v155, s5
    s_waitcnt vmcnt(8)
    v_mfma_f32_16x16x32_bf16 a[28:31], v[68:71], a[156:159], a[28:31]
    v_perm_b32 v64, v164, v160, s4
    v_mfma_f32_16x16x32_bf16 a[24:27], v[68:71], a[152:155], a[24:27]
    buffer_load_dwordx4 v[216:219], v5, s[44:47], s7 offen offset:1536
    v_mfma_f32_16x16x32_bf16 a[20:23], v[68:71], a[148:151], a[20:23]
    v_perm_b32 v65, v172, v168, s4
    v_perm_b32 v66, v180, v176, s4
    v_mfma_f32_16x16x32_bf16 a[16:19], v[68:71], a[144:147], a[16:19]
    v_perm_b32 v67, v188, v184, s4
    v_mfma_f32_16x16x32_bf16 a[32:35], v[72:75], a[144:147], a[32:35]
    ds_read_b128 a[132:135], v22
    buffer_load_dwordx4 v[220:223], v5, s[44:47], s7 offen offset:1792
    v_mfma_f32_16x16x32_bf16 a[36:39], v[72:75], a[148:151], a[36:39]
    v_perm_b32 v68, v164, v160, s5
    v_perm_b32 v69, v172, v168, s5
    v_mfma_f32_16x16x32_bf16 a[40:43], v[72:75], a[152:155], a[40:43]
    v_perm_b32 v70, v180, v176, s5
    v_mfma_f32_16x16x32_bf16 a[44:47], v[72:75], a[156:159], a[44:47]
    s_add_u32 s7, s83, 131072
    buffer_load_dwordx4 v[224:227], v5, s[44:47], s7 offen offset:0
    v_mfma_f32_16x16x32_bf16 a[60:63], v[76:79], a[156:159], a[60:63]
    v_perm_b32 v71, v188, v184, s5
    v_perm_b32 v72, v165, v161, s4
    v_mfma_f32_16x16x32_bf16 a[56:59], v[76:79], a[152:155], a[56:59]
    v_perm_b32 v73, v173, v169, s4
    v_mfma_f32_16x16x32_bf16 a[52:55], v[76:79], a[148:151], a[52:55]
    ds_read_b128 a[136:139], v26
    buffer_load_dwordx4 v[228:231], v5, s[44:47], s7 offen offset:256
    v_mfma_f32_16x16x32_bf16 a[48:51], v[76:79], a[144:147], a[48:51]
    v_perm_b32 v74, v181, v177, s4
    v_perm_b32 v75, v189, v185, s4
    v_mfma_f32_16x16x32_bf16 a[64:67], v[80:83], a[144:147], a[64:67]
    v_perm_b32 v76, v165, v161, s5
    v_mfma_f32_16x16x32_bf16 a[68:71], v[80:83], a[148:151], a[68:71]
    buffer_load_dwordx4 v[232:235], v5, s[44:47], s7 offen offset:512
    v_mfma_f32_16x16x32_bf16 a[72:75], v[80:83], a[152:155], a[72:75]
    v_perm_b32 v77, v173, v169, s5
    v_perm_b32 v78, v181, v177, s5
    v_mfma_f32_16x16x32_bf16 a[76:79], v[80:83], a[156:159], a[76:79]
    v_perm_b32 v79, v189, v185, s5
    v_mfma_f32_16x16x32_bf16 a[92:95], v[84:87], a[156:159], a[92:95]
    ds_read_b128 a[140:143], v30
    buffer_load_dwordx4 v[236:239], v5, s[44:47], s7 offen offset:768
    v_mfma_f32_16x16x32_bf16 a[88:91], v[84:87], a[152:155], a[88:91]
    v_perm_b32 v80, v166, v162, s4
    v_perm_b32 v81, v174, v170, s4
    v_mfma_f32_16x16x32_bf16 a[84:87], v[84:87], a[148:151], a[84:87]
    v_perm_b32 v82, v182, v178, s4
    v_mfma_f32_16x16x32_bf16 a[80:83], v[84:87], a[144:147], a[80:83]
    buffer_load_dwordx4 v[240:243], v5, s[44:47], s7 offen offset:1024
    v_mfma_f32_16x16x32_bf16 a[96:99], v[88:91], a[144:147], a[96:99]
    v_perm_b32 v83, v190, v186, s4
    v_perm_b32 v84, v166, v162, s5
    v_mfma_f32_16x16x32_bf16 a[100:103], v[88:91], a[148:151], a[100:103]
    v_perm_b32 v85, v174, v170, s5
    v_mfma_f32_16x16x32_bf16 a[104:107], v[88:91], a[152:155], a[104:107]
    buffer_load_dwordx4 v[244:247], v5, s[44:47], s7 offen offset:1280
    v_mfma_f32_16x16x32_bf16 a[108:111], v[88:91], a[156:159], a[108:111]
    v_perm_b32 v86, v182, v178, s5
    v_perm_b32 v87, v190, v186, s5
    v_mfma_f32_16x16x32_bf16 a[124:127], v[92:95], a[156:159], a[124:127]
    v_perm_b32 v88, v167, v163, s4
    v_mfma_f32_16x16x32_bf16 a[120:123], v[92:95], a[152:155], a[120:123]
    buffer_load_dwordx4 v[248:251], v5, s[44:47], s7 offen offset:1536
    v_mfma_f32_16x16x32_bf16 a[116:119], v[92:95], a[148:151], a[116:119]
    v_perm_b32 v89, v175, v171, s4
    v_perm_b32 v90, v183, v179, s4
    v_mfma_f32_16x16x32_bf16 a[112:115], v[92:95], a[144:147], a[112:115]
    v_perm_b32 v91, v191, v187, s4
    s_waitcnt lgkmcnt(3)
    v_mfma_f32_16x16x32_bf16 a[0:3], v[64:67], a[128:131], a[0:3]
    buffer_load_dwordx4 v[252:255], v5, s[44:47], s7 offen offset:1792
    s_waitcnt lgkmcnt(2)
    v_mfma_f32_16x16x32_bf16 a[4:7], v[64:67], a[132:135], a[4:7]
    v_perm_b32 v92, v167, v163, s5
    v_perm_b32 v93, v175, v171, s5
    s_waitcnt lgkmcnt(1)
    v_mfma_f32_16x16x32_bf16 a[8:11], v[64:67], a[136:139], a[8:11]
    ds_read_b128 a[144:147], v19
    v_perm_b32 v94, v183, v179, s5
    s_waitcnt lgkmcnt(1)
    v_mfma_f32_16x16x32_bf16 a[12:15], v[64:67], a[140:143], a[12:15]
    s_add_u32 s7, s83, 139264
    buffer_load_dwordx4 v[96:99], v5, s[44:47], s7 offen offset:0
    v_perm_b32 v95, v191, v187, s5
    s_waitcnt vmcnt(9)
    v_mfma_f32_16x16x32_bf16 a[28:31], v[68:71], a[140:143], a[28:31]
    ds_read_b128 v[16:19], v32 offset:64
    v_perm_b32 v64, v196, v192, s4
    v_mfma_f32_16x16x32_bf16 a[24:27], v[68:71], a[136:139], a[24:27]
    v_perm_b32 v65, v204, v200, s4
    v_mfma_f32_16x16x32_bf16 a[20:23], v[68:71], a[132:135], a[20:23]
    buffer_load_dwordx4 v[100:103], v5, s[44:47], s7 offen offset:256
    v_mfma_f32_16x16x32_bf16 a[16:19], v[68:71], a[128:131], a[16:19]
    v_perm_b32 v66, v212, v208, s4
    v_add_u32 v32, s92, v32
    v_perm_b32 v67, v220, v216, s4
    v_mfma_f32_16x16x32_bf16 a[32:35], v[72:75], a[128:131], a[32:35]
    ds_read_b128 a[148:151], v23
    v_perm_b32 v68, v196, v192, s5
    v_mfma_f32_16x16x32_bf16 a[36:39], v[72:75], a[132:135], a[36:39]
    buffer_load_dwordx4 v[104:107], v5, s[44:47], s7 offen offset:512
    v_perm_b32 v69, v204, v200, s5
    v_mfma_f32_16x16x32_bf16 a[40:43], v[72:75], a[136:139], a[40:43]
    ds_read_b128 v[20:23], v33 offset:64
    v_perm_b32 v70, v212, v208, s5
    v_mfma_f32_16x16x32_bf16 a[44:47], v[72:75], a[140:143], a[44:47]
    v_perm_b32 v71, v220, v216, s5
    v_mfma_f32_16x16x32_bf16 a[60:63], v[76:79], a[140:143], a[60:63]
    buffer_load_dwordx4 v[108:111], v5, s[44:47], s7 offen offset:768
    v_mfma_f32_16x16x32_bf16 a[56:59], v[76:79], a[136:139], a[56:59]
    v_perm_b32 v72, v197, v193, s4
    v_add_u32 v33, s92, v33
    v_perm_b32 v73, v205, v201, s4
    s_waitcnt lgkmcnt(2)
    v_lshl_add_u32 v16, v16, 4, v6
    v_mfma_f32_16x16x32_bf16 a[52:55], v[76:79], a[132:135], a[52:55]
    ds_read_b128 a[152:155], v27
    v_perm_b32 v74, v213, v209, s4
    v_mfma_f32_16x16x32_bf16 a[48:51], v[76:79], a[128:131], a[48:51]
    buffer_load_dwordx4 v[112:115], v5, s[44:47], s7 offen offset:1024
    v_perm_b32 v75, v221, v217, s4
    v_lshl_add_u32 v17, v17, 4, v6
    v_mfma_f32_16x16x32_bf16 a[64:67], v[80:83], a[128:131], a[64:67]
    ds_read_b128 v[24:27], v34 offset:64
    v_perm_b32 v76, v197, v193, s5
    v_mfma_f32_16x16x32_bf16 a[68:71], v[80:83], a[132:135], a[68:71]
    v_perm_b32 v77, v205, v201, s5
    v_lshl_add_u32 v18, v18, 4, v6
    v_mfma_f32_16x16x32_bf16 a[72:75], v[80:83], a[136:139], a[72:75]
    buffer_load_dwordx4 v[116:119], v5, s[44:47], s7 offen offset:1280
    v_mfma_f32_16x16x32_bf16 a[76:79], v[80:83], a[140:143], a[76:79]
    v_perm_b32 v78, v213, v209, s5
    v_add_u32 v34, s92, v34
    v_perm_b32 v79, v221, v217, s5
    v_lshl_add_u32 v19, v19, 4, v6
    s_waitcnt lgkmcnt(2)
    v_lshl_add_u32 v20, v20, 4, v6
    v_mfma_f32_16x16x32_bf16 a[92:95], v[84:87], a[140:143], a[92:95]
    ds_read_b128 a[156:159], v31
    v_perm_b32 v80, v198, v194, s4
    v_mfma_f32_16x16x32_bf16 a[88:91], v[84:87], a[136:139], a[88:91]
    buffer_load_dwordx4 v[120:123], v5, s[44:47], s7 offen offset:1536
    v_perm_b32 v81, v206, v202, s4
    v_lshl_add_u32 v21, v21, 4, v6
    v_mfma_f32_16x16x32_bf16 a[84:87], v[84:87], a[132:135], a[84:87]
    ds_read_b128 v[28:31], v35 offset:64
    v_perm_b32 v82, v214, v210, s4
    v_mfma_f32_16x16x32_bf16 a[80:83], v[84:87], a[128:131], a[80:83]
    v_perm_b32 v83, v222, v218, s4
    v_lshl_add_u32 v22, v22, 4, v6
    v_mfma_f32_16x16x32_bf16 a[96:99], v[88:91], a[128:131], a[96:99]
    buffer_load_dwordx4 v[124:127], v5, s[44:47], s7 offen offset:1792
    v_mfma_f32_16x16x32_bf16 a[100:103], v[88:91], a[132:135], a[100:103]
    v_perm_b32 v84, v198, v194, s5
    v_add_u32 v35, s92, v35
    v_perm_b32 v85, v206, v202, s5
    v_lshl_add_u32 v23, v23, 4, v6
    s_waitcnt lgkmcnt(2)
    v_lshl_add_u32 v24, v24, 4, v6
    v_mfma_f32_16x16x32_bf16 a[104:107], v[88:91], a[136:139], a[104:107]
    v_perm_b32 v86, v214, v210, s5
    v_mfma_f32_16x16x32_bf16 a[108:111], v[88:91], a[140:143], a[108:111]
    s_add_u32 s7, s83, 147456
    buffer_load_dwordx4 v[128:131], v5, s[44:47], s7 offen offset:0
    v_mfma_f32_16x16x32_bf16 a[124:127], v[92:95], a[140:143], a[124:127]
    v_perm_b32 v87, v222, v218, s5
    v_lshl_add_u32 v25, v25, 4, v6
    v_perm_b32 v88, v199, v195, s4
    v_mfma_f32_16x16x32_bf16 a[120:123], v[92:95], a[136:139], a[120:123]
    v_perm_b32 v89, v207, v203, s4
    v_lshl_add_u32 v26, v26, 4, v6
    v_mfma_f32_16x16x32_bf16 a[116:119], v[92:95], a[132:135], a[116:119]
    buffer_load_dwordx4 v[132:135], v5, s[44:47], s7 offen offset:256
    v_mfma_f32_16x16x32_bf16 a[112:115], v[92:95], a[128:131], a[112:115]
    v_perm_b32 v90, v215, v211, s4
    v_perm_b32 v91, v223, v219, s4
    v_lshl_add_u32 v27, v27, 4, v6
    s_waitcnt lgkmcnt(0)
    v_lshl_add_u32 v28, v28, 4, v6
    v_mfma_f32_16x16x32_bf16 a[0:3], v[64:67], a[144:147], a[0:3]
    v_perm_b32 v92, v199, v195, s5
    v_mfma_f32_16x16x32_bf16 a[4:7], v[64:67], a[148:151], a[4:7]
    v_perm_b32 v93, v207, v203, s5
    v_lshl_add_u32 v29, v29, 4, v6
    v_mfma_f32_16x16x32_bf16 a[8:11], v[64:67], a[152:155], a[8:11]
    ds_read_b128 a[128:131], v16
    buffer_load_dwordx4 v[136:139], v5, s[44:47], s7 offen offset:512
    v_mfma_f32_16x16x32_bf16 a[12:15], v[64:67], a[156:159], a[12:15]
    v_perm_b32 v94, v215, v211, s5
    v_perm_b32 v95, v223, v219, s5
    s_waitcnt vmcnt(11)
    v_lshl_add_u32 v30, v30, 4, v6
    v_mfma_f32_16x16x32_bf16 a[28:31], v[68:71], a[156:159], a[28:31]
    v_perm_b32 v64, v228, v224, s4
    v_mfma_f32_16x16x32_bf16 a[24:27], v[68:71], a[152:155], a[24:27]
    v_perm_b32 v65, v236, v232, s4
    v_lshl_add_u32 v31, v31, 4, v6
    v_mfma_f32_16x16x32_bf16 a[20:23], v[68:71], a[148:151], a[20:23]
    buffer_load_dwordx4 v[140:143], v5, s[44:47], s7 offen offset:768
    v_mfma_f32_16x16x32_bf16 a[16:19], v[68:71], a[144:147], a[16:19]
    v_perm_b32 v66, v244, v240, s4
    v_perm_b32 v67, v252, v248, s4
    v_mfma_f32_16x16x32_bf16 a[32:35], v[72:75], a[144:147], a[32:35]
    ds_read_b128 a[132:135], v20
    v_perm_b32 v68, v228, v224, s5
    v_mfma_f32_16x16x32_bf16 a[36:39], v[72:75], a[148:151], a[36:39]
    v_perm_b32 v69, v236, v232, s5
    v_mfma_f32_16x16x32_bf16 a[40:43], v[72:75], a[152:155], a[40:43]
    buffer_load_dwordx4 v[144:147], v5, s[44:47], s7 offen offset:1024
    v_mfma_f32_16x16x32_bf16 a[44:47], v[72:75], a[156:159], a[44:47]
    v_perm_b32 v70, v244, v240, s5
    v_perm_b32 v71, v252, v248, s5
    v_mfma_f32_16x16x32_bf16 a[60:63], v[76:79], a[156:159], a[60:63]
    v_perm_b32 v72, v229, v225, s4
    v_mfma_f32_16x16x32_bf16 a[56:59], v[76:79], a[152:155], a[56:59]
    v_perm_b32 v73, v237, v233, s4
    v_mfma_f32_16x16x32_bf16 a[52:55], v[76:79], a[148:151], a[52:55]
    ds_read_b128 a[136:139], v24
    buffer_load_dwordx4 v[148:151], v5, s[44:47], s7 offen offset:1280
    v_mfma_f32_16x16x32_bf16 a[48:51], v[76:79], a[144:147], a[48:51]
    v_perm_b32 v74, v245, v241, s4
    v_perm_b32 v75, v253, v249, s4
    v_mfma_f32_16x16x32_bf16 a[64:67], v[80:83], a[144:147], a[64:67]
    v_perm_b32 v76, v229, v225, s5
    v_mfma_f32_16x16x32_bf16 a[68:71], v[80:83], a[148:151], a[68:71]
    v_perm_b32 v77, v237, v233, s5
    v_mfma_f32_16x16x32_bf16 a[72:75], v[80:83], a[152:155], a[72:75]
    buffer_load_dwordx4 v[152:155], v5, s[44:47], s7 offen offset:1536
    v_mfma_f32_16x16x32_bf16 a[76:79], v[80:83], a[156:159], a[76:79]
    v_perm_b32 v78, v245, v241, s5
    v_perm_b32 v79, v253, v249, s5
    v_mfma_f32_16x16x32_bf16 a[92:95], v[84:87], a[156:159], a[92:95]
    ds_read_b128 a[140:143], v28
    v_perm_b32 v80, v230, v226, s4
    v_mfma_f32_16x16x32_bf16 a[88:91], v[84:87], a[152:155], a[88:91]
    buffer_load_dwordx4 v[156:159], v5, s[44:47], s7 offen offset:1792
    v_mfma_f32_16x16x32_bf16 a[84:87], v[84:87], a[148:151], a[84:87]
    v_perm_b32 v81, v238, v234, s4
    v_perm_b32 v82, v246, v242, s4
    v_mfma_f32_16x16x32_bf16 a[80:83], v[84:87], a[144:147], a[80:83]
    v_perm_b32 v83, v254, v250, s4
    v_mfma_f32_16x16x32_bf16 a[96:99], v[88:91], a[144:147], a[96:99]
    v_perm_b32 v84, v230, v226, s5
    v_mfma_f32_16x16x32_bf16 a[100:103], v[88:91], a[148:151], a[100:103]
    s_add_u32 s7, s83, 155648
    buffer_load_dwordx4 v[160:163], v5, s[44:47], s7 offen offset:0
    v_mfma_f32_16x16x32_bf16 a[104:107], v[88:91], a[152:155], a[104:107]
    v_perm_b32 v85, v238, v234, s5
    v_perm_b32 v86, v246, v242, s5
    v_mfma_f32_16x16x32_bf16 a[108:111], v[88:91], a[156:159], a[108:111]
    v_perm_b32 v87, v254, v250, s5
    v_mfma_f32_16x16x32_bf16 a[124:127], v[92:95], a[156:159], a[124:127]
    v_perm_b32 v88, v231, v227, s4
    v_mfma_f32_16x16x32_bf16 a[120:123], v[92:95], a[152:155], a[120:123]
    buffer_load_dwordx4 v[164:167], v5, s[44:47], s7 offen offset:256
    v_mfma_f32_16x16x32_bf16 a[116:119], v[92:95], a[148:151], a[116:119]
    v_perm_b32 v89, v239, v235, s4
    v_perm_b32 v90, v247, v243, s4
    v_mfma_f32_16x16x32_bf16 a[112:115], v[92:95], a[144:147], a[112:115]
    v_perm_b32 v91, v255, v251, s4
    s_waitcnt lgkmcnt(3)
    v_mfma_f32_16x16x32_bf16 a[0:3], v[64:67], a[128:131], a[0:3]
    v_perm_b32 v92, v231, v227, s5
    s_waitcnt lgkmcnt(2)
    v_mfma_f32_16x16x32_bf16 a[4:7], v[64:67], a[132:135], a[4:7]
    buffer_load_dwordx4 v[168:171], v5, s[44:47], s7 offen offset:512
    v_perm_b32 v93, v239, v235, s5
    s_waitcnt lgkmcnt(1)
    v_mfma_f32_16x16x32_bf16 a[8:11], v[64:67], a[136:139], a[8:11]
    ds_read_b128 a[144:147], v17
    v_perm_b32 v94, v247, v243, s5
    s_waitcnt lgkmcnt(1)
    v_mfma_f32_16x16x32_bf16 a[12:15], v[64:67], a[140:143], a[12:15]
    v_perm_b32 v95, v255, v251, s5
    s_waitcnt vmcnt(11)
    v_mfma_f32_16x16x32_bf16 a[28:31], v[68:71], a[140:143], a[28:31]
    v_perm_b32 v64, v100, v96, s4
    v_mfma_f32_16x16x32_bf16 a[24:27], v[68:71], a[136:139], a[24:27]
    buffer_load_dwordx4 v[172:175], v5, s[44:47], s7 offen offset:768
    v_mfma_f32_16x16x32_bf16 a[20:23], v[68:71], a[132:135], a[20:23]
    v_perm_b32 v65, v108, v104, s4
    v_perm_b32 v66, v116, v112, s4
    v_mfma_f32_16x16x32_bf16 a[16:19], v[68:71], a[128:131], a[16:19]
    v_perm_b32 v67, v124, v120, s4
    v_mfma_f32_16x16x32_bf16 a[32:35], v[72:75], a[128:131], a[32:35]
    ds_read_b128 a[148:151], v21
    v_perm_b32 v68, v100, v96, s5
    v_mfma_f32_16x16x32_bf16 a[36:39], v[72:75], a[132:135], a[36:39]
    buffer_load_dwordx4 v[176:179], v5, s[44:47], s7 offen offset:1024
    v_mfma_f32_16x16x32_bf16 a[40:43], v[72:75], a[136:139], a[40:43]
    v_perm_b32 v69, v108, v104, s5
    v_perm_b32 v70, v116, v112, s5
    v_mfma_f32_16x16x32_bf16 a[44:47], v[72:75], a[140:143], a[44:47]
    v_perm_b32 v71, v124, v120, s5
    v_mfma_f32_16x16x32_bf16 a[60:63], v[76:79], a[140:143], a[60:63]
    v_perm_b32 v72, v101, v97, s4
    v_mfma_f32_16x16x32_bf16 a[56:59], v[76:79], a[136:139], a[56:59]
    buffer_load_dwordx4 v[180:183], v5, s[44:47], s7 offen offset:1280
    v_perm_b32 v73, v109, v105, s4
    v_mfma_f32_16x16x32_bf16 a[52:55], v[76:79], a[132:135], a[52:55]
    ds_read_b128 a[152:155], v25
    v_perm_b32 v74, v117, v113, s4
    v_mfma_f32_16x16x32_bf16 a[48:51], v[76:79], a[128:131], a[48:51]
    v_perm_b32 v75, v125, v121, s4
    v_mfma_f32_16x16x32_bf16 a[64:67], v[80:83], a[128:131], a[64:67]
    buffer_load_dwordx4 v[184:187], v5, s[44:47], s7 offen offset:1536
    v_mfma_f32_16x16x32_bf16 a[68:71], v[80:83], a[132:135], a[68:71]
    v_perm_b32 v76, v101, v97, s5
    v_perm_b32 v77, v109, v105, s5
    v_mfma_f32_16x16x32_bf16 a[72:75], v[80:83], a[136:139], a[72:75]
    v_perm_b32 v78, v117, v113, s5
    v_mfma_f32_16x16x32_bf16 a[76:79], v[80:83], a[140:143], a[76:79]
    v_perm_b32 v79, v125, v121, s5
    v_mfma_f32_16x16x32_bf16 a[92:95], v[84:87], a[140:143], a[92:95]
    ds_read_b128 a[156:159], v29
    buffer_load_dwordx4 v[188:191], v5, s[44:47], s7 offen offset:1792
    v_mfma_f32_16x16x32_bf16 a[88:91], v[84:87], a[136:139], a[88:91]
    v_perm_b32 v80, v102, v98, s4
    v_perm_b32 v81, v110, v106, s4
    v_mfma_f32_16x16x32_bf16 a[84:87], v[84:87], a[132:135], a[84:87]
    v_perm_b32 v82, v118, v114, s4
    v_mfma_f32_16x16x32_bf16 a[80:83], v[84:87], a[128:131], a[80:83]
    v_perm_b32 v83, v126, v122, s4
    v_mfma_f32_16x16x32_bf16 a[96:99], v[88:91], a[128:131], a[96:99]
    s_add_u32 s7, s8, 262144
    buffer_load_dwordx4 v[192:195], v5, s[44:47], s7 offen offset:0
    v_mfma_f32_16x16x32_bf16 a[100:103], v[88:91], a[132:135], a[100:103]
    v_perm_b32 v84, v102, v98, s5
    v_perm_b32 v85, v110, v106, s5
    v_mfma_f32_16x16x32_bf16 a[104:107], v[88:91], a[136:139], a[104:107]
    v_perm_b32 v86, v118, v114, s5
    v_mfma_f32_16x16x32_bf16 a[108:111], v[88:91], a[140:143], a[108:111]
    v_perm_b32 v87, v126, v122, s5
    v_mfma_f32_16x16x32_bf16 a[124:127], v[92:95], a[140:143], a[124:127]
    buffer_load_dwordx4 v[196:199], v5, s[44:47], s7 offen offset:256
    v_mfma_f32_16x16x32_bf16 a[120:123], v[92:95], a[136:139], a[120:123]
    v_perm_b32 v88, v103, v99, s4
    v_perm_b32 v89, v111, v107, s4
    v_mfma_f32_16x16x32_bf16 a[116:119], v[92:95], a[132:135], a[116:119]
    v_perm_b32 v90, v119, v115, s4
    v_mfma_f32_16x16x32_bf16 a[112:115], v[92:95], a[128:131], a[112:115]
    v_perm_b32 v91, v127, v123, s4
    s_waitcnt lgkmcnt(3)
    v_mfma_f32_16x16x32_bf16 a[0:3], v[64:67], a[144:147], a[0:3]
    buffer_load_dwordx4 v[200:203], v5, s[44:47], s7 offen offset:512
    s_waitcnt lgkmcnt(2)
    v_mfma_f32_16x16x32_bf16 a[4:7], v[64:67], a[148:151], a[4:7]
    v_perm_b32 v92, v103, v99, s5
    v_perm_b32 v93, v111, v107, s5
    s_waitcnt lgkmcnt(1)
    v_mfma_f32_16x16x32_bf16 a[8:11], v[64:67], a[152:155], a[8:11]
    ds_read_b128 a[128:131], v18
    v_perm_b32 v94, v119, v115, s5
    s_waitcnt lgkmcnt(1)
    v_mfma_f32_16x16x32_bf16 a[12:15], v[64:67], a[156:159], a[12:15]
    v_perm_b32 v95, v127, v123, s5
    s_waitcnt vmcnt(11)
    v_mfma_f32_16x16x32_bf16 a[28:31], v[68:71], a[156:159], a[28:31]
    buffer_load_dwordx4 v[204:207], v5, s[44:47], s7 offen offset:768
    v_mfma_f32_16x16x32_bf16 a[24:27], v[68:71], a[152:155], a[24:27]
    v_perm_b32 v64, v132, v128, s4
    v_perm_b32 v65, v140, v136, s4
    v_mfma_f32_16x16x32_bf16 a[20:23], v[68:71], a[148:151], a[20:23]
    v_perm_b32 v66, v148, v144, s4
    v_mfma_f32_16x16x32_bf16 a[16:19], v[68:71], a[144:147], a[16:19]
    v_perm_b32 v67, v156, v152, s4
    v_mfma_f32_16x16x32_bf16 a[32:35], v[72:75], a[144:147], a[32:35]
    ds_read_b128 a[132:135], v22
    buffer_load_dwordx4 v[208:211], v5, s[44:47], s7 offen offset:1024
    v_mfma_f32_16x16x32_bf16 a[36:39], v[72:75], a[148:151], a[36:39]
    v_perm_b32 v68, v132, v128, s5
    v_perm_b32 v69, v140, v136, s5
    v_mfma_f32_16x16x32_bf16 a[40:43], v[72:75], a[152:155], a[40:43]
    v_perm_b32 v70, v148, v144, s5
    v_mfma_f32_16x16x32_bf16 a[44:47], v[72:75], a[156:159], a[44:47]
    buffer_load_dwordx4 v[212:215], v5, s[44:47], s7 offen offset:1280
    v_mfma_f32_16x16x32_bf16 a[60:63], v[76:79], a[156:159], a[60:63]
    v_perm_b32 v71, v156, v152, s5
    v_perm_b32 v72, v133, v129, s4
    v_mfma_f32_16x16x32_bf16 a[56:59], v[76:79], a[152:155], a[56:59]
    v_perm_b32 v73, v141, v137, s4
    v_mfma_f32_16x16x32_bf16 a[52:55], v[76:79], a[148:151], a[52:55]
    ds_read_b128 a[136:139], v26
    v_perm_b32 v74, v149, v145, s4
    v_mfma_f32_16x16x32_bf16 a[48:51], v[76:79], a[144:147], a[48:51]
    buffer_load_dwordx4 v[216:219], v5, s[44:47], s7 offen offset:1536
    v_mfma_f32_16x16x32_bf16 a[64:67], v[80:83], a[144:147], a[64:67]
    v_perm_b32 v75, v157, v153, s4
    v_perm_b32 v76, v133, v129, s5
    v_mfma_f32_16x16x32_bf16 a[68:71], v[80:83], a[148:151], a[68:71]
    v_perm_b32 v77, v141, v137, s5
    v_mfma_f32_16x16x32_bf16 a[72:75], v[80:83], a[152:155], a[72:75]
    v_perm_b32 v78, v149, v145, s5
    v_mfma_f32_16x16x32_bf16 a[76:79], v[80:83], a[156:159], a[76:79]
    buffer_load_dwordx4 v[220:223], v5, s[44:47], s7 offen offset:1792
    v_perm_b32 v79, v157, v153, s5
    v_mfma_f32_16x16x32_bf16 a[92:95], v[84:87], a[156:159], a[92:95]
    ds_read_b128 a[140:143], v30
    v_perm_b32 v80, v134, v130, s4
    v_mfma_f32_16x16x32_bf16 a[88:91], v[84:87], a[152:155], a[88:91]
    v_perm_b32 v81, v142, v138, s4
    v_mfma_f32_16x16x32_bf16 a[84:87], v[84:87], a[148:151], a[84:87]
    v_perm_b32 v82, v150, v146, s4
    v_mfma_f32_16x16x32_bf16 a[80:83], v[84:87], a[144:147], a[80:83]
    s_add_u32 s7, s8, 270336
    buffer_load_dwordx4 v[224:227], v5, s[44:47], s7 offen offset:0
    v_mfma_f32_16x16x32_bf16 a[96:99], v[88:91], a[144:147], a[96:99]
    v_perm_b32 v83, v158, v154, s4
    v_perm_b32 v84, v134, v130, s5
    v_mfma_f32_16x16x32_bf16 a[100:103], v[88:91], a[148:151], a[100:103]
    v_perm_b32 v85, v142, v138, s5
    v_mfma_f32_16x16x32_bf16 a[104:107], v[88:91], a[152:155], a[104:107]
    v_perm_b32 v86, v150, v146, s5
    v_mfma_f32_16x16x32_bf16 a[108:111], v[88:91], a[156:159], a[108:111]
    buffer_load_dwordx4 v[228:231], v5, s[44:47], s7 offen offset:256
    v_mfma_f32_16x16x32_bf16 a[124:127], v[92:95], a[156:159], a[124:127]
    v_perm_b32 v87, v158, v154, s5
    v_perm_b32 v88, v135, v131, s4
    v_mfma_f32_16x16x32_bf16 a[120:123], v[92:95], a[152:155], a[120:123]
    v_perm_b32 v89, v143, v139, s4
    v_mfma_f32_16x16x32_bf16 a[116:119], v[92:95], a[148:151], a[116:119]
    v_perm_b32 v90, v151, v147, s4
    v_mfma_f32_16x16x32_bf16 a[112:115], v[92:95], a[144:147], a[112:115]
    buffer_load_dwordx4 v[232:235], v5, s[44:47], s7 offen offset:512
    v_perm_b32 v91, v159, v155, s4
    s_waitcnt lgkmcnt(3)
    v_mfma_f32_16x16x32_bf16 a[0:3], v[64:67], a[128:131], a[0:3]
    v_perm_b32 v92, v135, v131, s5
    s_waitcnt lgkmcnt(2)
    v_mfma_f32_16x16x32_bf16 a[4:7], v[64:67], a[132:135], a[4:7]
    v_perm_b32 v93, v143, v139, s5
    s_waitcnt lgkmcnt(1)
    v_mfma_f32_16x16x32_bf16 a[8:11], v[64:67], a[136:139], a[8:11]
    ds_read_b128 a[144:147], v19
    buffer_load_dwordx4 v[236:239], v5, s[44:47], s7 offen offset:768
    s_waitcnt lgkmcnt(1)
    v_mfma_f32_16x16x32_bf16 a[12:15], v[64:67], a[140:143], a[12:15]
    v_perm_b32 v94, v151, v147, s5
    v_perm_b32 v95, v159, v155, s5
    s_waitcnt vmcnt(12)
    v_mfma_f32_16x16x32_bf16 a[28:31], v[68:71], a[140:143], a[28:31]
    ds_read_b128 v[16:19], v32 offset:128
    v_perm_b32 v64, v164, v160, s4
    v_mfma_f32_16x16x32_bf16 a[24:27], v[68:71], a[136:139], a[24:27]
    v_perm_b32 v65, v172, v168, s4
    v_mfma_f32_16x16x32_bf16 a[20:23], v[68:71], a[132:135], a[20:23]
    buffer_load_dwordx4 v[240:243], v5, s[44:47], s7 offen offset:1024
    v_mfma_f32_16x16x32_bf16 a[16:19], v[68:71], a[128:131], a[16:19]
    v_perm_b32 v66, v180, v176, s4
    v_subrev_u32 v32, s92, v32
    v_perm_b32 v67, v188, v184, s4
    v_mfma_f32_16x16x32_bf16 a[32:35], v[72:75], a[128:131], a[32:35]
    ds_read_b128 a[148:151], v23
    v_perm_b32 v68, v164, v160, s5
    v_mfma_f32_16x16x32_bf16 a[36:39], v[72:75], a[132:135], a[36:39]
    v_perm_b32 v69, v172, v168, s5
    v_mfma_f32_16x16x32_bf16 a[40:43], v[72:75], a[136:139], a[40:43]
    ds_read_b128 v[20:23], v33 offset:128
    buffer_load_dwordx4 v[244:247], v5, s[44:47], s7 offen offset:1280
    v_mfma_f32_16x16x32_bf16 a[44:47], v[72:75], a[140:143], a[44:47]
    v_perm_b32 v70, v180, v176, s5
    v_perm_b32 v71, v188, v184, s5
    v_mfma_f32_16x16x32_bf16 a[60:63], v[76:79], a[140:143], a[60:63]
    v_perm_b32 v72, v165, v161, s4
    v_subrev_u32 v33, s92, v33
    v_mfma_f32_16x16x32_bf16 a[56:59], v[76:79], a[136:139], a[56:59]
    v_perm_b32 v73, v173, v169, s4
    s_waitcnt lgkmcnt(2)
    v_lshl_add_u32 v16, v16, 4, v6
    v_mfma_f32_16x16x32_bf16 a[52:55], v[76:79], a[132:135], a[52:55]
    ds_read_b128 a[152:155], v27
    buffer_load_dwordx4 v[248:251], v5, s[44:47], s7 offen offset:1536
    v_mfma_f32_16x16x32_bf16 a[48:51], v[76:79], a[128:131], a[48:51]
    v_perm_b32 v74, v181, v177, s4
    v_perm_b32 v75, v189, v185, s4
    v_lshl_add_u32 v17, v17, 4, v6
    v_mfma_f32_16x16x32_bf16 a[64:67], v[80:83], a[128:131], a[64:67]
    ds_read_b128 v[24:27], v34 offset:128
    v_perm_b32 v76, v165, v161, s5
    v_mfma_f32_16x16x32_bf16 a[68:71], v[80:83], a[132:135], a[68:71]
    v_perm_b32 v77, v173, v169, s5
    v_lshl_add_u32 v18, v18, 4, v6
    v_mfma_f32_16x16x32_bf16 a[72:75], v[80:83], a[136:139], a[72:75]
    buffer_load_dwordx4 v[252:255], v5, s[44:47], s7 offen offset:1792
    v_mfma_f32_16x16x32_bf16 a[76:79], v[80:83], a[140:143], a[76:79]
    v_perm_b32 v78, v181, v177, s5
    v_subrev_u32 v34, s92, v34
    v_perm_b32 v79, v189, v185, s5
    v_lshl_add_u32 v19, v19, 4, v6
    s_waitcnt lgkmcnt(2)
    v_lshl_add_u32 v20, v20, 4, v6
    v_mfma_f32_16x16x32_bf16 a[92:95], v[84:87], a[140:143], a[92:95]
    ds_read_b128 a[156:159], v31
    v_perm_b32 v80, v166, v162, s4
    v_mfma_f32_16x16x32_bf16 a[88:91], v[84:87], a[136:139], a[88:91]
    v_perm_b32 v81, v174, v170, s4
    v_lshl_add_u32 v21, v21, 4, v6
    v_mfma_f32_16x16x32_bf16 a[84:87], v[84:87], a[132:135], a[84:87]
    ds_read_b128 v[28:31], v35 offset:128
    s_add_u32 s7, s8, 278528
    buffer_load_dwordx4 v[96:99], v5, s[44:47], s7 offen offset:0
    v_mfma_f32_16x16x32_bf16 a[80:83], v[84:87], a[128:131], a[80:83]
    v_perm_b32 v82, v182, v178, s4
    v_perm_b32 v83, v190, v186, s4
    v_lshl_add_u32 v22, v22, 4, v6
    v_mfma_f32_16x16x32_bf16 a[96:99], v[88:91], a[128:131], a[96:99]
    v_perm_b32 v84, v166, v162, s5
    v_subrev_u32 v35, s92, v35
    v_mfma_f32_16x16x32_bf16 a[100:103], v[88:91], a[132:135], a[100:103]
    v_perm_b32 v85, v174, v170, s5
    v_lshl_add_u32 v23, v23, 4, v6
    s_waitcnt lgkmcnt(2)
    v_lshl_add_u32 v24, v24, 4, v6
    v_mfma_f32_16x16x32_bf16 a[104:107], v[88:91], a[136:139], a[104:107]
    buffer_load_dwordx4 v[100:103], v5, s[44:47], s7 offen offset:256
    v_mfma_f32_16x16x32_bf16 a[108:111], v[88:91], a[140:143], a[108:111]
    v_perm_b32 v86, v182, v178, s5
    v_perm_b32 v87, v190, v186, s5
    v_lshl_add_u32 v25, v25, 4, v6
    v_mfma_f32_16x16x32_bf16 a[124:127], v[92:95], a[140:143], a[124:127]
    v_perm_b32 v88, v167, v163, s4
    v_mfma_f32_16x16x32_bf16 a[120:123], v[92:95], a[136:139], a[120:123]
    buffer_load_dwordx4 v[104:107], v5, s[44:47], s7 offen offset:512
    v_mfma_f32_16x16x32_bf16 a[116:119], v[92:95], a[132:135], a[116:119]
    v_perm_b32 v89, v175, v171, s4
    v_lshl_add_u32 v26, v26, 4, v6
    v_perm_b32 v90, v183, v179, s4
    v_mfma_f32_16x16x32_bf16 a[112:115], v[92:95], a[128:131], a[112:115]
    v_perm_b32 v91, v191, v187, s4
    v_lshl_add_u32 v27, v27, 4, v6
    s_waitcnt lgkmcnt(0)
    v_lshl_add_u32 v28, v28, 4, v6
    v_mfma_f32_16x16x32_bf16 a[0:3], v[64:67], a[144:147], a[0:3]
    v_perm_b32 v92, v167, v163, s5
    v_mfma_f32_16x16x32_bf16 a[4:7], v[64:67], a[148:151], a[4:7]
    buffer_load_dwordx4 v[108:111], v5, s[44:47], s7 offen offset:768
    v_perm_b32 v93, v175, v171, s5
    v_lshl_add_u32 v29, v29, 4, v6
    v_mfma_f32_16x16x32_bf16 a[8:11], v[64:67], a[152:155], a[8:11]
    ds_read_b128 a[128:131], v16
    v_perm_b32 v94, v183, v179, s5
    v_mfma_f32_16x16x32_bf16 a[12:15], v[64:67], a[156:159], a[12:15]
    v_perm_b32 v95, v191, v187, s5
    s_waitcnt vmcnt(12)
    v_lshl_add_u32 v30, v30, 4, v6
    v_mfma_f32_16x16x32_bf16 a[28:31], v[68:71], a[156:159], a[28:31]
    v_perm_b32 v64, v196, v192, s4
    v_mfma_f32_16x16x32_bf16 a[24:27], v[68:71], a[152:155], a[24:27]
    buffer_load_dwordx4 v[112:115], v5, s[44:47], s7 offen offset:1024
    v_mfma_f32_16x16x32_bf16 a[20:23], v[68:71], a[148:151], a[20:23]
    v_perm_b32 v65, v204, v200, s4
    v_lshl_add_u32 v31, v31, 4, v6
    v_perm_b32 v66, v212, v208, s4
    v_mfma_f32_16x16x32_bf16 a[16:19], v[68:71], a[144:147], a[16:19]
    v_perm_b32 v67, v220, v216, s4
    v_mfma_f32_16x16x32_bf16 a[32:35], v[72:75], a[144:147], a[32:35]
    ds_read_b128 a[132:135], v20
    v_perm_b32 v68, v196, v192, s5
    v_alignbit_b32 v48, v49, v48, v56
    v_mfma_f32_16x16x32_bf16 a[36:39], v[72:75], a[148:151], a[36:39]
    buffer_load_dwordx4 v[116:119], v5, s[44:47], s7 offen offset:1280
    v_mfma_f32_16x16x32_bf16 a[40:43], v[72:75], a[152:155], a[40:43]
    v_perm_b32 v69, v204, v200, s5
    v_perm_b32 v70, v212, v208, s5
    v_alignbit_b32 v49, v50, v49, v56
    v_mfma_f32_16x16x32_bf16 a[44:47], v[72:75], a[156:159], a[44:47]
    v_perm_b32 v71, v220, v216, s5
    v_mfma_f32_16x16x32_bf16 a[60:63], v[76:79], a[156:159], a[60:63]
    v_perm_b32 v72, v197, v193, s4
    v_alignbit_b32 v50, v51, v50, v56
    v_mfma_f32_16x16x32_bf16 a[56:59], v[76:79], a[152:155], a[56:59]
    buffer_load_dwordx4 v[120:123], v5, s[44:47], s7 offen offset:1536
    v_perm_b32 v73, v205, v201, s4
    v_mfma_f32_16x16x32_bf16 a[52:55], v[76:79], a[148:151], a[52:55]
    ds_read_b128 a[136:139], v24
    v_perm_b32 v74, v213, v209, s4
    v_alignbit_b32 v51, v52, v51, v56
    v_mfma_f32_16x16x32_bf16 a[48:51], v[76:79], a[144:147], a[48:51]
    v_perm_b32 v75, v221, v217, s4
    v_mfma_f32_16x16x32_bf16 a[64:67], v[80:83], a[144:147], a[64:67]
    v_perm_b32 v76, v197, v193, s5
    v_alignbit_b32 v52, v53, v52, v56
    v_mfma_f32_16x16x32_bf16 a[68:71], v[80:83], a[148:151], a[68:71]
    buffer_load_dwordx4 v[124:127], v5, s[44:47], s7 offen offset:1792
    v_mfma_f32_16x16x32_bf16 a[72:75], v[80:83], a[152:155], a[72:75]
    v_perm_b32 v77, v205, v201, s5
    v_perm_b32 v78, v213, v209, s5
    v_alignbit_b32 v53, v54, v53, v56
    v_mfma_f32_16x16x32_bf16 a[76:79], v[80:83], a[156:159], a[76:79]
    v_perm_b32 v79, v221, v217, s5
    v_mfma_f32_16x16x32_bf16 a[92:95], v[84:87], a[156:159], a[92:95]
    ds_read_b128 a[140:143], v28
    v_perm_b32 v80, v198, v194, s4
    v_alignbit_b32 v54, v55, v54, v56
    v_mfma_f32_16x16x32_bf16 a[88:91], v[84:87], a[152:155], a[88:91]
    s_add_u32 s7, s8, 286720
    buffer_load_dwordx4 v[128:131], v5, s[44:47], s7 offen offset:0
    v_mfma_f32_16x16x32_bf16 a[84:87], v[84:87], a[148:151], a[84:87]
    v_perm_b32 v81, v206, v202, s4
    v_perm_b32 v82, v214, v210, s4
    v_mov_b32 v57, 0
    v_mfma_f32_16x16x32_bf16 a[80:83], v[84:87], a[144:147], a[80:83]
    v_perm_b32 v83, v222, v218, s4
    v_mfma_f32_16x16x32_bf16 a[96:99], v[88:91], a[144:147], a[96:99]
    buffer_load_dwordx4 v[132:135], v5, s[44:47], s7 offen offset:256
    v_mfma_f32_16x16x32_bf16 a[100:103], v[88:91], a[148:151], a[100:103]
    v_perm_b32 v84, v198, v194, s5
    s_lshl_b32 s9, s72, 16
    v_lshlrev_b32 v2, 16, v48
    v_perm_b32 v85, v206, v202, s5
    v_mfma_f32_16x16x32_bf16 a[104:107], v[88:91], a[152:155], a[104:107]
    v_perm_b32 v86, v214, v210, s5
    v_fmac_f32 v57, s9, v2
    v_mfma_f32_16x16x32_bf16 a[108:111], v[88:91], a[156:159], a[108:111]
    v_perm_b32 v87, v222, v218, s5
    v_mfma_f32_16x16x32_bf16 a[124:127], v[92:95], a[156:159], a[124:127]
    s_mov_b32 s12, 524288
    buffer_load_dword v62, v60, s[44:47], s12 offen
    v_mfma_f32_16x16x32_bf16 a[120:123], v[92:95], a[152:155], a[120:123]
    v_perm_b32 v88, v199, v195, s4
    s_and_b32 s9, s72, 0xffff0000
    v_and_b32 v2, 0xffff0000, v48
    v_perm_b32 v89, v207, v203, s4
    v_mfma_f32_16x16x32_bf16 a[116:119], v[92:95], a[148:151], a[116:119]
    v_perm_b32 v90, v215, v211, s4
    v_fmac_f32 v57, s9, v2
    v_mfma_f32_16x16x32_bf16 a[112:115], v[92:95], a[144:147], a[112:115]
    v_perm_b32 v91, v223, v219, s4
    s_waitcnt lgkmcnt(3)
    v_mfma_f32_16x16x32_bf16 a[0:3], v[64:67], a[128:131], a[0:3]
    s_mov_b32 s12, 655360
    buffer_load_dword v62, v60, s[44:47], s12 offen
    s_waitcnt lgkmcnt(2)
    v_mfma_f32_16x16x32_bf16 a[4:7], v[64:67], a[132:135], a[4:7]
    v_perm_b32 v92, v199, v195, s5
    s_lshl_b32 s9, s73, 16
    v_lshlrev_b32 v2, 16, v49
    v_perm_b32 v93, v207, v203, s5
    s_waitcnt lgkmcnt(1)
    v_mfma_f32_16x16x32_bf16 a[8:11], v[64:67], a[136:139], a[8:11]
    ds_read_b128 a[144:147], v17
    v_perm_b32 v94, v215, v211, s5
    v_fmac_f32 v57, s9, v2
    s_waitcnt lgkmcnt(1)
    v_mfma_f32_16x16x32_bf16 a[12:15], v[64:67], a[140:143], a[12:15]
    v_perm_b32 v95, v223, v219, s5
    s_waitcnt vmcnt(12)
    v_mfma_f32_16x16x32_bf16 a[28:31], v[68:71], a[140:143], a[28:31]
    buffer_load_dwordx4 v[136:139], v5, s[44:47], s7 offen offset:512
    v_mfma_f32_16x16x32_bf16 a[24:27], v[68:71], a[136:139], a[24:27]
    v_perm_b32 v64, v228, v224, s4
    s_and_b32 s9, s73, 0xffff0000
    v_and_b32 v2, 0xffff0000, v49
    v_perm_b32 v65, v236, v232, s4
    v_mfma_f32_16x16x32_bf16 a[20:23], v[68:71], a[132:135], a[20:23]
    v_perm_b32 v66, v244, v240, s4
    v_fmac_f32 v57, s9, v2
    v_mfma_f32_16x16x32_bf16 a[16:19], v[68:71], a[128:131], a[16:19]
    v_perm_b32 v67, v252, v248, s4
    v_mfma_f32_16x16x32_bf16 a[32:35], v[72:75], a[128:131], a[32:35]
    ds_read_b128 a[148:151], v21
    buffer_load_dwordx4 v[140:143], v5, s[44:47], s7 offen offset:768
    v_mfma_f32_16x16x32_bf16 a[36:39], v[72:75], a[132:135], a[36:39]
    v_perm_b32 v68, v228, v224, s5
    s_lshl_b32 s9, s74, 16
    v_lshlrev_b32 v2, 16, v50
    v_perm_b32 v69, v236, v232, s5
    v_mfma_f32_16x16x32_bf16 a[40:43], v[72:75], a[136:139], a[40:43]
    v_perm_b32 v70, v244, v240, s5
    v_fmac_f32 v57, s9, v2
    v_mfma_f32_16x16x32_bf16 a[44:47], v[72:75], a[140:143], a[44:47]
    v_perm_b32 v71, v252, v248, s5
    v_mfma_f32_16x16x32_bf16 a[60:63], v[76:79], a[140:143], a[60:63]
    buffer_load_dwordx4 v[144:147], v5, s[44:47], s7 offen offset:1024
    v_mfma_f32_16x16x32_bf16 a[56:59], v[76:79], a[136:139], a[56:59]
    v_perm_b32 v72, v229, v225, s4
    s_and_b32 s9, s74, 0xffff0000
    v_and_b32 v2, 0xffff0000, v50
    v_perm_b32 v73, v237, v233, s4
    v_mfma_f32_16x16x32_bf16 a[52:55], v[76:79], a[132:135], a[52:55]
    ds_read_b128 a[152:155], v25
    v_perm_b32 v74, v245, v241, s4
    v_fmac_f32 v57, s9, v2
    v_mfma_f32_16x16x32_bf16 a[48:51], v[76:79], a[128:131], a[48:51]
    buffer_load_dwordx4 v[148:151], v5, s[44:47], s7 offen offset:1280
    v_mfma_f32_16x16x32_bf16 a[64:67], v[80:83], a[128:131], a[64:67]
    v_perm_b32 v75, v253, v249, s4
    v_perm_b32 v76, v229, v225, s5
    s_lshl_b32 s9, s75, 16
    v_lshlrev_b32 v2, 16, v51
    v_mfma_f32_16x16x32_bf16 a[68:71], v[80:83], a[132:135], a[68:71]
    v_perm_b32 v77, v237, v233, s5
    v_mfma_f32_16x16x32_bf16 a[72:75], v[80:83], a[136:139], a[72:75]
    v_perm_b32 v78, v245, v241, s5
    v_fmac_f32 v57, s9, v2
    v_mfma_f32_16x16x32_bf16 a[76:79], v[80:83], a[140:143], a[76:79]
    buffer_load_dwordx4 v[152:155], v5, s[44:47], s7 offen offset:1536
    v_perm_b32 v79, v253, v249, s5
    v_mfma_f32_16x16x32_bf16 a[92:95], v[84:87], a[140:143], a[92:95]
    ds_read_b128 a[156:159], v29
    v_perm_b32 v80, v230, v226, s4
    s_and_b32 s9, s75, 0xffff0000
    v_and_b32 v2, 0xffff0000, v51
    v_mfma_f32_16x16x32_bf16 a[88:91], v[84:87], a[136:139], a[88:91]
    v_perm_b32 v81, v238, v234, s4
    v_mfma_f32_16x16x32_bf16 a[84:87], v[84:87], a[132:135], a[84:87]
    v_perm_b32 v82, v246, v242, s4
    v_fmac_f32 v57, s9, v2
    v_mfma_f32_16x16x32_bf16 a[80:83], v[84:87], a[128:131], a[80:83]
    buffer_load_dwordx4 v[156:159], v5, s[44:47], s7 offen offset:1792
    v_mfma_f32_16x16x32_bf16 a[96:99], v[88:91], a[128:131], a[96:99]
    v_perm_b32 v83, v254, v250, s4
    v_perm_b32 v84, v230, v226, s5
    s_lshl_b32 s9, s76, 16
    v_lshlrev_b32 v2, 16, v52
    v_mfma_f32_16x16x32_bf16 a[100:103], v[88:91], a[132:135], a[100:103]
    v_perm_b32 v85, v238, v234, s5
    v_mfma_f32_16x16x32_bf16 a[104:107], v[88:91], a[136:139], a[104:107]
    v_perm_b32 v86, v246, v242, s5
    v_fmac_f32 v57, s9, v2
    v_mfma_f32_16x16x32_bf16 a[108:111], v[88:91], a[140:143], a[108:111]
    s_add_u32 s7, s83, 393216
    buffer_load_dwordx4 v[160:163], v5, s[44:47], s7 offen offset:0
    v_mfma_f32_16x16x32_bf16 a[124:127], v[92:95], a[140:143], a[124:127]
    v_perm_b32 v87, v254, v250, s5
    v_perm_b32 v88, v231, v227, s4
    s_and_b32 s9, s76, 0xffff0000
    v_and_b32 v2, 0xffff0000, v52
    v_mfma_f32_16x16x32_bf16 a[120:123], v[92:95], a[136:139], a[120:123]
    v_perm_b32 v89, v239, v235, s4
    v_mfma_f32_16x16x32_bf16 a[116:119], v[92:95], a[132:135], a[116:119]
    v_perm_b32 v90, v247, v243, s4
    v_fmac_f32 v57, s9, v2
    v_mfma_f32_16x16x32_bf16 a[112:115], v[92:95], a[128:131], a[112:115]
    buffer_load_dwordx4 v[164:167], v5, s[44:47], s7 offen offset:256
    v_perm_b32 v91, v255, v251, s4
    s_waitcnt lgkmcnt(3)
    v_mfma_f32_16x16x32_bf16 a[0:3], v[64:67], a[144:147], a[0:3]
    v_perm_b32 v92, v231, v227, s5
    s_lshl_b32 s9, s77, 16
    v_lshlrev_b32 v2, 16, v53
    s_waitcnt lgkmcnt(2)
    v_mfma_f32_16x16x32_bf16 a[4:7], v[64:67], a[148:151], a[4:7]
    v_perm_b32 v93, v239, v235, s5
    s_waitcnt lgkmcnt(1)
    v_mfma_f32_16x16x32_bf16 a[8:11], v[64:67], a[152:155], a[8:11]
    ds_read_b128 a[128:131], v18
    v_perm_b32 v94, v247, v243, s5
    v_fmac_f32 v57, s9, v2
    s_waitcnt lgkmcnt(1)
    v_mfma_f32_16x16x32_bf16 a[12:15], v[64:67], a[156:159], a[12:15]
    buffer_load_dwordx4 v[168:171], v5, s[44:47], s7 offen offset:512
    v_mfma_f32_16x16x32_bf16 a[28:31], v[68:71], a[156:159], a[28:31]
    v_perm_b32 v95, v255, v251, s5
    s_waitcnt vmcnt(13)
    v_perm_b32 v64, v100, v96, s4
    s_and_b32 s9, s77, 0xffff0000
    v_and_b32 v2, 0xffff0000, v53
    v_mfma_f32_16x16x32_bf16 a[24:27], v[68:71], a[152:155], a[24:27]
    v_perm_b32 v65, v108, v104, s4
    v_mfma_f32_16x16x32_bf16 a[20:23], v[68:71], a[148:151], a[20:23]
    v_perm_b32 v66, v116, v112, s4
    v_fmac_f32 v57, s9, v2
    v_mfma_f32_16x16x32_bf16 a[16:19], v[68:71], a[144:147], a[16:19]
    buffer_load_dwordx4 v[172:175], v5, s[44:47], s7 offen offset:768
    v_perm_b32 v67, v124, v120, s4
    v_mfma_f32_16x16x32_bf16 a[32:35], v[72:75], a[144:147], a[32:35]
    ds_read_b128 a[132:135], v22
    v_perm_b32 v68, v100, v96, s5
    s_lshl_b32 s9, s78, 16
    v_lshlrev_b32 v2, 16, v54
    v_mfma_f32_16x16x32_bf16 a[36:39], v[72:75], a[148:151], a[36:39]
    v_perm_b32 v69, v108, v104, s5
    v_mfma_f32_16x16x32_bf16 a[40:43], v[72:75], a[152:155], a[40:43]
    buffer_load_dwordx4 v[176:179], v5, s[44:47], s7 offen offset:1024
    v_mfma_f32_16x16x32_bf16 a[44:47], v[72:75], a[156:159], a[44:47]
    v_perm_b32 v70, v116, v112, s5
    v_fmac_f32 v57, s9, v2
    v_perm_b32 v71, v124, v120, s5
    v_mfma_f32_16x16x32_bf16 a[60:63], v[76:79], a[156:159], a[60:63]
    v_perm_b32 v72, v101, v97, s4
    v_cvt_pk_bf16_f32 v57, v57, v57
    v_mfma_f32_16x16x32_bf16 a[56:59], v[76:79], a[152:155], a[56:59]
    v_perm_b32 v73, v109, v105, s4
    v_mfma_f32_16x16x32_bf16 a[52:55], v[76:79], a[148:151], a[52:55]
    ds_read_b128 a[136:139], v26
    buffer_load_dwordx4 v[180:183], v5, s[44:47], s7 offen offset:1280
    v_mfma_f32_16x16x32_bf16 a[48:51], v[76:79], a[144:147], a[48:51]
    v_perm_b32 v74, v117, v113, s4
    v_lshlrev_b32 v57, 16, v57
    s_lshl_b32 s9, s80, 16
    v_perm_b32 v75, v125, v121, s4
    v_mfma_f32_16x16x32_bf16 a[64:67], v[80:83], a[144:147], a[64:67]
    v_perm_b32 v76, v101, v97, s5
    v_add_f32 v57, s9, v57
    v_mfma_f32_16x16x32_bf16 a[68:71], v[80:83], a[148:151], a[68:71]
    v_perm_b32 v77, v109, v105, s5
    v_mfma_f32_16x16x32_bf16 a[72:75], v[80:83], a[152:155], a[72:75]
    buffer_load_dwordx4 v[184:187], v5, s[44:47], s7 offen offset:1536
    v_mfma_f32_16x16x32_bf16 a[76:79], v[80:83], a[156:159], a[76:79]
    v_perm_b32 v78, v117, v113, s5
    v_cvt_pk_bf16_f32 v57, v57, v57
    v_perm_b32 v79, v125, v121, s5
    v_mfma_f32_16x16x32_bf16 a[92:95], v[84:87], a[156:159], a[92:95]
    ds_read_b128 a[140:143], v30
    v_perm_b32 v80, v102, v98, s4
    v_lshlrev_b32 v57, 16, v57
    v_mfma_f32_16x16x32_bf16 a[88:91], v[84:87], a[152:155], a[88:91]
    v_perm_b32 v81, v110, v106, s4
    v_mfma_f32_16x16x32_bf16 a[84:87], v[84:87], a[148:151], a[84:87]
    buffer_load_dwordx4 v[188:191], v5, s[44:47], s7 offen offset:1792
    v_mfma_f32_16x16x32_bf16 a[80:83], v[84:87], a[144:147], a[80:83]
    v_perm_b32 v82, v118, v114, s4
    v_add_u32 v2, 162944, v8
    v_perm_b32 v83, v126, v122, s4
    v_mfma_f32_16x16x32_bf16 a[96:99], v[88:91], a[144:147], a[96:99]
    v_perm_b32 v84, v102, v98, s5
    s_cmp_lg_u32 s3, 3
    s_cbranch_scc1 L_nowide
    ds_write_b32 v2, v57
L_nowide:
    v_mfma_f32_16x16x32_bf16 a[100:103], v[88:91], a[148:151], a[100:103]
    v_perm_b32 v85, v110, v106, s5
    v_mfma_f32_16x16x32_bf16 a[104:107], v[88:91], a[152:155], a[104:107]
    s_add_u32 s7, s83, 401408
    buffer_load_dwordx4 v[192:195], v5, s[44:47], s7 offen offset:0
    v_mfma_f32_16x16x32_bf16 a[108:111], v[88:91], a[156:159], a[108:111]
    v_perm_b32 v86, v118, v114, s5
    v_perm_b32 v87, v126, v122, s5
    v_mfma_f32_16x16x32_bf16 a[124:127], v[92:95], a[156:159], a[124:127]
    v_perm_b32 v88, v103, v99, s4
    v_mfma_f32_16x16x32_bf16 a[120:123], v[92:95], a[152:155], a[120:123]
    v_perm_b32 v89, v111, v107, s4
    v_mfma_f32_16x16x32_bf16 a[116:119], v[92:95], a[148:151], a[116:119]
    buffer_load_dwordx4 v[196:199], v5, s[44:47], s7 offen offset:256
    v_mfma_f32_16x16x32_bf16 a[112:115], v[92:95], a[144:147], a[112:115]
    v_perm_b32 v90, v119, v115, s4
    v_perm_b32 v91, v127, v123, s4
    s_waitcnt lgkmcnt(3)
    v_mfma_f32_16x16x32_bf16 a[0:3], v[64:67], a[128:131], a[0:3]
    v_perm_b32 v92, v103, v99, s5
    s_waitcnt lgkmcnt(2)
    v_mfma_f32_16x16x32_bf16 a[4:7], v[64:67], a[132:135], a[4:7]
    v_perm_b32 v93, v111, v107, s5
    s_waitcnt lgkmcnt(1)
    v_mfma_f32_16x16x32_bf16 a[8:11], v[64:67], a[136:139], a[8:11]
    ds_read_b128 a[144:147], v19
    buffer_load_dwordx4 v[200:203], v5, s[44:47], s7 offen offset:512
    s_waitcnt lgkmcnt(1)
    v_mfma_f32_16x16x32_bf16 a[12:15], v[64:67], a[140:143], a[12:15]
    v_perm_b32 v94, v119, v115, s5
    v_perm_b32 v95, v127, v123, s5
    s_waitcnt vmcnt(11)
    v_mfma_f32_16x16x32_bf16 a[28:31], v[68:71], a[140:143], a[28:31]
    ds_read_b128 v[16:19], v32 offset:192
    v_perm_b32 v64, v132, v128, s4
    v_mfma_f32_16x16x32_bf16 a[24:27], v[68:71], a[136:139], a[24:27]
    buffer_load_dwordx4 v[204:207], v5, s[44:47], s7 offen offset:768
    v_mfma_f32_16x16x32_bf16 a[20:23], v[68:71], a[132:135], a[20:23]
    v_perm_b32 v65, v140, v136, s4
    v_perm_b32 v66, v148, v144, s4
    v_add_u32 v32, s92, v32
    v_mfma_f32_16x16x32_bf16 a[16:19], v[68:71], a[128:131], a[16:19]
    v_perm_b32 v67, v156, v152, s4
    v_mfma_f32_16x16x32_bf16 a[32:35], v[72:75], a[128:131], a[32:35]
    ds_read_b128 a[148:151], v23
    v_perm_b32 v68, v132, v128, s5
    v_mfma_f32_16x16x32_bf16 a[36:39], v[72:75], a[132:135], a[36:39]
    buffer_load_dwordx4 v[208:211], v5, s[44:47], s7 offen offset:1024
    v_perm_b32 v69, v140, v136, s5
    v_mfma_f32_16x16x32_bf16 a[40:43], v[72:75], a[136:139], a[40:43]
    ds_read_b128 v[20:23], v33 offset:192
    v_perm_b32 v70, v148, v144, s5
    v_mfma_f32_16x16x32_bf16 a[44:47], v[72:75], a[140:143], a[44:47]
    v_perm_b32 v71, v156, v152, s5
    v_mfma_f32_16x16x32_bf16 a[60:63], v[76:79], a[140:143], a[60:63]
    v_perm_b32 v72, v133, v129, s4
    v_add_u32 v33, s92, v33
    v_mfma_f32_16x16x32_bf16 a[56:59], v[76:79], a[136:139], a[56:59]
    buffer_load_dwordx4 v[212:215], v5, s[44:47], s7 offen offset:1280
    v_perm_b32 v73, v141, v137, s4
    s_waitcnt lgkmcnt(2)
    v_lshl_add_u32 v16, v16, 4, v6
    v_mfma_f32_16x16x32_bf16 a[52:55], v[76:79], a[132:135], a[52:55]
    ds_read_b128 a[152:155], v27
    v_perm_b32 v74, v149, v145, s4
    v_mfma_f32_16x16x32_bf16 a[48:51], v[76:79], a[128:131], a[48:51]
    v_perm_b32 v75, v157, v153, s4
    v_lshl_add_u32 v17, v17, 4, v6
    v_mfma_f32_16x16x32_bf16 a[64:67], v[80:83], a[128:131], a[64:67]
    ds_read_b128 v[24:27], v34 offset:192
    v_perm_b32 v76, v133, v129, s5
    v_mfma_f32_16x16x32_bf16 a[68:71], v[80:83], a[132:135], a[68:71]
    buffer_load_dwordx4 v[216:219], v5, s[44:47], s7 offen offset:1536
    v_mfma_f32_16x16x32_bf16 a[72:75], v[80:83], a[136:139], a[72:75]
    v_perm_b32 v77, v141, v137, s5
    v_lshl_add_u32 v18, v18, 4, v6
    v_perm_b32 v78, v149, v145, s5
    v_add_u32 v34, s92, v34
    v_mfma_f32_16x16x32_bf16 a[76:79], v[80:83], a[140:143], a[76:79]
    v_perm_b32 v79, v157, v153, s5
    v_lshl_add_u32 v19, v19, 4, v6
    s_waitcnt lgkmcnt(2)
    v_lshl_add_u32 v20, v20, 4, v6
    v_mfma_f32_16x16x32_bf16 a[92:95], v[84:87], a[140:143], a[92:95]
    ds_read_b128 a[156:159], v31
    v_perm_b32 v80, v134, v130, s4
    v_mfma_f32_16x16x32_bf16 a[88:91], v[84:87], a[136:139], a[88:91]
    buffer_load_dwordx4 v[220:223], v5, s[44:47], s7 offen offset:1792
    v_perm_b32 v81, v142, v138, s4
    v_lshl_add_u32 v21, v21, 4, v6
    v_mfma_f32_16x16x32_bf16 a[84:87], v[84:87], a[132:135], a[84:87]
    ds_read_b128 v[28:31], v35 offset:192
    v_perm_b32 v82, v150, v146, s4
    v_mfma_f32_16x16x32_bf16 a[80:83], v[84:87], a[128:131], a[80:83]
    v_perm_b32 v83, v158, v154, s4
    v_lshl_add_u32 v22, v22, 4, v6
    v_mfma_f32_16x16x32_bf16 a[96:99], v[88:91], a[128:131], a[96:99]
    v_perm_b32 v84, v134, v130, s5
    v_add_u32 v35, s92, v35
    v_mfma_f32_16x16x32_bf16 a[100:103], v[88:91], a[132:135], a[100:103]
    s_add_u32 s7, s83, 409600
    buffer_load_dwordx4 v[224:227], v5, s[44:47], s7 offen offset:0
    v_mfma_f32_16x16x32_bf16 a[104:107], v[88:91], a[136:139], a[104:107]
    v_perm_b32 v85, v142, v138, s5
    v_lshl_add_u32 v23, v23, 4, v6
    s_waitcnt lgkmcnt(2)
    v_lshl_add_u32 v24, v24, 4, v6
    v_perm_b32 v86, v150, v146, s5
    v_mfma_f32_16x16x32_bf16 a[108:111], v[88:91], a[140:143], a[108:111]
    v_perm_b32 v87, v158, v154, s5
    v_lshl_add_u32 v25, v25, 4, v6
    v_mfma_f32_16x16x32_bf16 a[124:127], v[92:95], a[140:143], a[124:127]
    buffer_load_dwordx4 v[228:231], v5, s[44:47], s7 offen offset:256
    v_mfma_f32_16x16x32_bf16 a[120:123], v[92:95], a[136:139], a[120:123]
    v_perm_b32 v88, v135, v131, s4
    v_perm_b32 v89, v143, v139, s4
    v_lshl_add_u32 v26, v26, 4, v6
    v_mfma_f32_16x16x32_bf16 a[116:119], v[92:95], a[132:135], a[116:119]
    v_perm_b32 v90, v151, v147, s4
    v_mfma_f32_16x16x32_bf16 a[112:115], v[92:95], a[128:131], a[112:115]
    v_perm_b32 v91, v159, v155, s4
    v_lshl_add_u32 v27, v27, 4, v6
    s_waitcnt lgkmcnt(0)
    v_lshl_add_u32 v28, v28, 4, v6
    v_mfma_f32_16x16x32_bf16 a[0:3], v[64:67], a[144:147], a[0:3]
    buffer_load_dwordx4 v[232:235], v5, s[44:47], s7 offen offset:512
    v_mfma_f32_16x16x32_bf16 a[4:7], v[64:67], a[148:151], a[4:7]
    v_perm_b32 v92, v135, v131, s5
    v_perm_b32 v93, v143, v139, s5
    v_lshl_add_u32 v29, v29, 4, v6
    v_mfma_f32_16x16x32_bf16 a[8:11], v[64:67], a[152:155], a[8:11]
    ds_read_b128 a[128:131], v16
    v_perm_b32 v94, v151, v147, s5
    v_mfma_f32_16x16x32_bf16 a[12:15], v[64:67], a[156:159], a[12:15]
    v_perm_b32 v95, v159, v155, s5
    s_waitcnt vmcnt(11)
    v_lshl_add_u32 v30, v30, 4, v6
    v_mfma_f32_16x16x32_bf16 a[28:31], v[68:71], a[156:159], a[28:31]
    buffer_load_dwordx4 v[236:239], v5, s[44:47], s7 offen offset:768
    v_mfma_f32_16x16x32_bf16 a[24:27], v[68:71], a[152:155], a[24:27]
    v_perm_b32 v64, v164, v160, s4
    v_perm_b32 v65, v172, v168, s4
    v_lshl_add_u32 v31, v31, 4, v6
    v_mfma_f32_16x16x32_bf16 a[20:23], v[68:71], a[148:151], a[20:23]
    v_perm_b32 v66, v180, v176, s4
    v_mfma_f32_16x16x32_bf16 a[16:19], v[68:71], a[144:147], a[16:19]
    v_perm_b32 v67, v188, v184, s4
    v_mfma_f32_16x16x32_bf16 a[32:35], v[72:75], a[144:147], a[32:35]
    ds_read_b128 a[132:135], v20
    buffer_load_dwordx4 v[240:243], v5, s[44:47], s7 offen offset:1024
    v_mfma_f32_16x16x32_bf16 a[36:39], v[72:75], a[148:151], a[36:39]
    v_perm_b32 v68, v164, v160, s5
    v_perm_b32 v69, v172, v168, s5
    v_mfma_f32_16x16x32_bf16 a[40:43], v[72:75], a[152:155], a[40:43]
    v_perm_b32 v70, v180, v176, s5
    v_mfma_f32_16x16x32_bf16 a[44:47], v[72:75], a[156:159], a[44:47]
    v_perm_b32 v71, v188, v184, s5
    v_mfma_f32_16x16x32_bf16 a[60:63], v[76:79], a[156:159], a[60:63]
    buffer_load_dwordx4 v[244:247], v5, s[44:47], s7 offen offset:1280
    v_mfma_f32_16x16x32_bf16 a[56:59], v[76:79], a[152:155], a[56:59]
    v_perm_b32 v72, v165, v161, s4
    v_perm_b32 v73, v173, v169, s4
    v_mfma_f32_16x16x32_bf16 a[52:55], v[76:79], a[148:151], a[52:55]
    ds_read_b128 a[136:139], v24
    v_perm_b32 v74, v181, v177, s4
    v_mfma_f32_16x16x32_bf16 a[48:51], v[76:79], a[144:147], a[48:51]
    v_perm_b32 v75, v189, v185, s4
    v_mfma_f32_16x16x32_bf16 a[64:67], v[80:83], a[144:147], a[64:67]
    buffer_load_dwordx4 v[248:251], v5, s[44:47], s7 offen offset:1536
    v_mfma_f32_16x16x32_bf16 a[68:71], v[80:83], a[148:151], a[68:71]
    v_perm_b32 v76, v165, v161, s5
    v_perm_b32 v77, v173, v169, s5
    v_mfma_f32_16x16x32_bf16 a[72:75], v[80:83], a[152:155], a[72:75]
    v_perm_b32 v78, v181, v177, s5
    v_mfma_f32_16x16x32_bf16 a[76:79], v[80:83], a[156:159], a[76:79]
    v_perm_b32 v79, v189, v185, s5
    v_mfma_f32_16x16x32_bf16 a[92:95], v[84:87], a[156:159], a[92:95]
    ds_read_b128 a[140:143], v28
    buffer_load_dwordx4 v[252:255], v5, s[44:47], s7 offen offset:1792
    v_mfma_f32_16x16x32_bf16 a[88:91], v[84:87], a[152:155], a[88:91]
    v_perm_b32 v80, v166, v162, s4
    v_perm_b32 v81, v174, v170, s4
    v_mfma_f32_16x16x32_bf16 a[84:87], v[84:87], a[148:151], a[84:87]
    v_perm_b32 v82, v182, v178, s4
    v_mfma_f32_16x16x32_bf16 a[80:83], v[84:87], a[144:147], a[80:83]
    s_add_u32 s7, s83, 417792
    buffer_load_dwordx4 v[96:99], v5, s[44:47], s7 offen offset:0
    v_mfma_f32_16x16x32_bf16 a[96:99], v[88:91], a[144:147], a[96:99]
    v_perm_b32 v83, v190, v186, s4
    v_perm_b32 v84, v166, v162, s5
    v_mfma_f32_16x16x32_bf16 a[100:103], v[88:91], a[148:151], a[100:103]
    v_perm_b32 v85, v174, v170, s5
    v_mfma_f32_16x16x32_bf16 a[104:107], v[88:91], a[152:155], a[104:107]
    v_perm_b32 v86, v182, v178, s5
    v_mfma_f32_16x16x32_bf16 a[108:111], v[88:91], a[156:159], a[108:111]
    buffer_load_dwordx4 v[100:103], v5, s[44:47], s7 offen offset:256
    v_mfma_f32_16x16x32_bf16 a[124:127], v[92:95], a[156:159], a[124:127]
    v_perm_b32 v87, v190, v186, s5
    v_perm_b32 v88, v167, v163, s4
    v_mfma_f32_16x16x32_bf16 a[120:123], v[92:95], a[152:155], a[120:123]
    v_perm_b32 v89, v175, v171, s4
    v_mfma_f32_16x16x32_bf16 a[116:119], v[92:95], a[148:151], a[116:119]
    v_perm_b32 v90, v183, v179, s4
    v_mfma_f32_16x16x32_bf16 a[112:115], v[92:95], a[144:147], a[112:115]
    buffer_load_dwordx4 v[104:107], v5, s[44:47], s7 offen offset:512
    v_perm_b32 v91, v191, v187, s4
    s_waitcnt lgkmcnt(3)
    v_mfma_f32_16x16x32_bf16 a[0:3], v[64:67], a[128:131], a[0:3]
    v_perm_b32 v92, v167, v163, s5
    s_waitcnt lgkmcnt(2)
    v_mfma_f32_16x16x32_bf16 a[4:7], v[64:67], a[132:135], a[4:7]
    v_perm_b32 v93, v175, v171, s5
    s_waitcnt lgkmcnt(1)
    v_mfma_f32_16x16x32_bf16 a[8:11], v[64:67], a[136:139], a[8:11]
    ds_read_b128 a[144:147], v17
    v_perm_b32 v94, v183, v179, s5
    s_waitcnt lgkmcnt(1)
    v_mfma_f32_16x16x32_bf16 a[12:15], v[64:67], a[140:143], a[12:15]
    buffer_load_dwordx4 v[108:111], v5, s[44:47], s7 offen offset:768
    v_mfma_f32_16x16x32_bf16 a[28:31], v[68:71], a[140:143], a[28:31]
    v_perm_b32 v95, v191, v187, s5
    s_waitcnt vmcnt(12)
    v_perm_b32 v64, v196, v192, s4
    v_mfma_f32_16x16x32_bf16 a[24:27], v[68:71], a[136:139], a[24:27]
    v_perm_b32 v65, v204, v200, s4
    v_mfma_f32_16x16x32_bf16 a[20:23], v[68:71], a[132:135], a[20:23]
    v_perm_b32 v66, v212, v208, s4
    v_mfma_f32_16x16x32_bf16 a[16:19], v[68:71], a[128:131], a[16:19]
    buffer_load_dwordx4 v[112:115], v5, s[44:47], s7 offen offset:1024
    v_perm_b32 v67, v220, v216, s4
    v_mfma_f32_16x16x32_bf16 a[32:35], v[72:75], a[128:131], a[32:35]
    ds_read_b128 a[148:151], v21
    v_perm_b32 v68, v196, v192, s5
    v_mfma_f32_16x16x32_bf16 a[36:39], v[72:75], a[132:135], a[36:39]
    v_perm_b32 v69, v204, v200, s5
    v_mfma_f32_16x16x32_bf16 a[40:43], v[72:75], a[136:139], a[40:43]
    v_perm_b32 v70, v212, v208, s5
    v_mfma_f32_16x16x32_bf16 a[44:47], v[72:75], a[140:143], a[44:47]
    buffer_load_dwordx4 v[116:119], v5, s[44:47], s7 offen offset:1280
    v_mfma_f32_16x16x32_bf16 a[60:63], v[76:79], a[140:143], a[60:63]
    v_perm_b32 v71, v220, v216, s5
    v_perm_b32 v72, v197, v193, s4
    v_mfma_f32_16x16x32_bf16 a[56:59], v[76:79], a[136:139], a[56:59]
    v_perm_b32 v73, v205, v201, s4
    v_mfma_f32_16x16x32_bf16 a[52:55], v[76:79], a[132:135], a[52:55]
    ds_read_b128 a[152:155], v25
    v_perm_b32 v74, v213, v209, s4
    v_mfma_f32_16x16x32_bf16 a[48:51], v[76:79], a[128:131], a[48:51]
    buffer_load_dwordx4 v[120:123], v5, s[44:47], s7 offen offset:1536
    v_mfma_f32_16x16x32_bf16 a[64:67], v[80:83], a[128:131], a[64:67]
    v_perm_b32 v75, v221, v217, s4
    v_perm_b32 v76, v197, v193, s5
    v_mfma_f32_16x16x32_bf16 a[68:71], v[80:83], a[132:135], a[68:71]
    v_perm_b32 v77, v205, v201, s5
    v_mfma_f32_16x16x32_bf16 a[72:75], v[80:83], a[136:139], a[72:75]
    buffer_load_dwordx4 v[124:127], v5, s[44:47], s7 offen offset:1792
    v_mfma_f32_16x16x32_bf16 a[76:79], v[80:83], a[140:143], a[76:79]
    v_perm_b32 v78, v213, v209, s5
    v_perm_b32 v79, v221, v217, s5
    v_mfma_f32_16x16x32_bf16 a[92:95], v[84:87], a[140:143], a[92:95]
    ds_read_b128 a[156:159], v29
    v_perm_b32 v80, v198, v194, s4
    v_mfma_f32_16x16x32_bf16 a[88:91], v[84:87], a[136:139], a[88:91]
    v_perm_b32 v81, v206, v202, s4
    v_mfma_f32_16x16x32_bf16 a[84:87], v[84:87], a[132:135], a[84:87]
    s_add_u32 s7, s8, 524288
    buffer_load_dwordx4 v[128:131], v5, s[44:47], s7 offen offset:0
    v_mfma_f32_16x16x32_bf16 a[80:83], v[84:87], a[128:131], a[80:83]
    v_perm_b32 v82, v214, v210, s4
    v_perm_b32 v83, v222, v218, s4
    v_mfma_f32_16x16x32_bf16 a[96:99], v[88:91], a[128:131], a[96:99]
    v_perm_b32 v84, v198, v194, s5
    v_mfma_f32_16x16x32_bf16 a[100:103], v[88:91], a[132:135], a[100:103]
    v_perm_b32 v85, v206, v202, s5
    v_mfma_f32_16x16x32_bf16 a[104:107], v[88:91], a[136:139], a[104:107]
    buffer_load_dwordx4 v[132:135], v5, s[44:47], s7 offen offset:256
    v_mfma_f32_16x16x32_bf16 a[108:111], v[88:91], a[140:143], a[108:111]
    v_perm_b32 v86, v214, v210, s5
    v_perm_b32 v87, v222, v218, s5
    v_mfma_f32_16x16x32_bf16 a[124:127], v[92:95], a[140:143], a[124:127]
    v_perm_b32 v88, v199, v195, s4
    v_mfma_f32_16x16x32_bf16 a[120:123], v[92:95], a[136:139], a[120:123]
    v_perm_b32 v89, v207, v203, s4
    v_mfma_f32_16x16x32_bf16 a[116:119], v[92:95], a[132:135], a[116:119]
    s_mov_b32 s12, 786432
    buffer_load_dword v62, v60, s[44:47], s12 offen
    v_mfma_f32_16x16x32_bf16 a[112:115], v[92:95], a[128:131], a[112:115]
    v_perm_b32 v90, v215, v211, s4
    v_perm_b32 v91, v223, v219, s4
    s_waitcnt lgkmcnt(3)
    v_mfma_f32_16x16x32_bf16 a[0:3], v[64:67], a[144:147], a[0:3]
    v_perm_b32 v92, v199, v195, s5
    s_waitcnt lgkmcnt(2)
    v_mfma_f32_16x16x32_bf16 a[4:7], v[64:67], a[148:151], a[4:7]
    v_perm_b32 v93, v207, v203, s5
    s_waitcnt lgkmcnt(1)
    v_mfma_f32_16x16x32_bf16 a[8:11], v[64:67], a[152:155], a[8:11]
    ds_read_b128 a[128:131], v18
    buffer_load_dwordx4 v[136:139], v5, s[44:47], s7 offen offset:512
    s_waitcnt lgkmcnt(1)
    v_mfma_f32_16x16x32_bf16 a[12:15], v[64:67], a[156:159], a[12:15]
    v_perm_b32 v94, v215, v211, s5
    v_perm_b32 v95, v223, v219, s5
    s_waitcnt vmcnt(12)
    v_mfma_f32_16x16x32_bf16 a[28:31], v[68:71], a[156:159], a[28:31]
    v_perm_b32 v64, v228, v224, s4
    v_mfma_f32_16x16x32_bf16 a[24:27], v[68:71], a[152:155], a[24:27]
    v_perm_b32 v65, v236, v232, s4
    v_mfma_f32_16x16x32_bf16 a[20:23], v[68:71], a[148:151], a[20:23]
    buffer_load_dwordx4 v[140:143], v5, s[44:47], s7 offen offset:768
    v_mfma_f32_16x16x32_bf16 a[16:19], v[68:71], a[144:147], a[16:19]
    v_perm_b32 v66, v244, v240, s4
    v_perm_b32 v67, v252, v248, s4
    v_mfma_f32_16x16x32_bf16 a[32:35], v[72:75], a[144:147], a[32:35]
    ds_read_b128 a[132:135], v22
    v_perm_b32 v68, v228, v224, s5
    v_mfma_f32_16x16x32_bf16 a[36:39], v[72:75], a[148:151], a[36:39]
    buffer_load_dwordx4 v[144:147], v5, s[44:47], s7 offen offset:1024
    v_mfma_f32_16x16x32_bf16 a[40:43], v[72:75], a[152:155], a[40:43]
    v_perm_b32 v69, v236, v232, s5
    v_perm_b32 v70, v244, v240, s5
    v_mfma_f32_16x16x32_bf16 a[44:47], v[72:75], a[156:159], a[44:47]
    v_perm_b32 v71, v252, v248, s5
    v_mfma_f32_16x16x32_bf16 a[60:63], v[76:79], a[156:159], a[60:63]
    v_perm_b32 v72, v229, v225, s4
    v_mfma_f32_16x16x32_bf16 a[56:59], v[76:79], a[152:155], a[56:59]
    buffer_load_dwordx4 v[148:151], v5, s[44:47], s7 offen offset:1280
    v_perm_b32 v73, v237, v233, s4
    v_mfma_f32_16x16x32_bf16 a[52:55], v[76:79], a[148:151], a[52:55]
    ds_read_b128 a[136:139], v26
    v_perm_b32 v74, v245, v241, s4
    v_mfma_f32_16x16x32_bf16 a[48:51], v[76:79], a[144:147], a[48:51]
    v_perm_b32 v75, v253, v249, s4
    v_mfma_f32_16x16x32_bf16 a[64:67], v[80:83], a[144:147], a[64:67]
    v_perm_b32 v76, v229, v225, s5
    v_mfma_f32_16x16x32_bf16 a[68:71], v[80:83], a[148:151], a[68:71]
    buffer_load_dwordx4 v[152:155], v5, s[44:47], s7 offen offset:1536
    v_mfma_f32_16x16x32_bf16 a[72:75], v[80:83], a[152:155], a[72:75]
    v_perm_b32 v77, v237, v233, s5
    v_perm_b32 v78, v245, v241, s5
    v_mfma_f32_16x16x32_bf16 a[76:79], v[80:83], a[156:159], a[76:79]
    v_perm_b32 v79, v253, v249, s5
    v_mfma_f32_16x16x32_bf16 a[92:95], v[84:87], a[156:159], a[92:95]
    ds_read_b128 a[140:143], v30
    v_perm_b32 v80, v230, v226, s4
    v_mfma_f32_16x16x32_bf16 a[88:91], v[84:87], a[152:155], a[88:91]
    buffer_load_dwordx4 v[156:159], v5, s[44:47], s7 offen offset:1792
    v_mfma_f32_16x16x32_bf16 a[84:87], v[84:87], a[148:151], a[84:87]
    v_perm_b32 v81, v238, v234, s4
    v_perm_b32 v82, v246, v242, s4
    v_mfma_f32_16x16x32_bf16 a[80:83], v[84:87], a[144:147], a[80:83]
    v_perm_b32 v83, v254, v250, s4
    v_mfma_f32_16x16x32_bf16 a[96:99], v[88:91], a[144:147], a[96:99]
    v_perm_b32 v84, v230, v226, s5
    v_mfma_f32_16x16x32_bf16 a[100:103], v[88:91], a[148:151], a[100:103]
    s_add_u32 s7, s8, 532480
    buffer_load_dwordx4 v[160:163], v5, s[44:47], s7 offen offset:0
    v_mfma_f32_16x16x32_bf16 a[104:107], v[88:91], a[152:155], a[104:107]
    v_perm_b32 v85, v238, v234, s5
    v_perm_b32 v86, v246, v242, s5
    v_mfma_f32_16x16x32_bf16 a[108:111], v[88:91], a[156:159], a[108:111]
    v_perm_b32 v87, v254, v250, s5
    v_mfma_f32_16x16x32_bf16 a[124:127], v[92:95], a[156:159], a[124:127]
    v_perm_b32 v88, v231, v227, s4
    v_mfma_f32_16x16x32_bf16 a[120:123], v[92:95], a[152:155], a[120:123]
    buffer_load_dwordx4 v[164:167], v5, s[44:47], s7 offen offset:256
    v_mfma_f32_16x16x32_bf16 a[116:119], v[92:95], a[148:151], a[116:119]
    v_perm_b32 v89, v239, v235, s4
    v_perm_b32 v90, v247, v243, s4
    v_mfma_f32_16x16x32_bf16 a[112:115], v[92:95], a[144:147], a[112:115]
    v_perm_b32 v91, v255, v251, s4
    s_waitcnt lgkmcnt(3)
    v_mfma_f32_16x16x32_bf16 a[0:3], v[64:67], a[128:131], a[0:3]
    v_perm_b32 v92, v231, v227, s5
    s_waitcnt lgkmcnt(2)
    v_mfma_f32_16x16x32_bf16 a[4:7], v[64:67], a[132:135], a[4:7]
    buffer_load_dwordx4 v[168:171], v5, s[44:47], s7 offen offset:512
    v_perm_b32 v93, v239, v235, s5
    s_waitcnt lgkmcnt(1)
    v_mfma_f32_16x16x32_bf16 a[8:11], v[64:67], a[136:139], a[8:11]
    ds_read_b128 a[144:147], v19
    v_perm_b32 v94, v247, v243, s5
    s_waitcnt lgkmcnt(1)
    v_mfma_f32_16x16x32_bf16 a[12:15], v[64:67], a[140:143], a[12:15]
    v_perm_b32 v95, v255, v251, s5
    s_waitcnt vmcnt(12)
    v_mfma_f32_16x16x32_bf16 a[28:31], v[68:71], a[140:143], a[28:31]
    ds_read_b128 v[16:19], v32 offset:256
    buffer_load_dwordx4 v[172:175], v5, s[44:47], s7 offen offset:768
    v_mfma_f32_16x16x32_bf16 a[24:27], v[68:71], a[136:139], a[24:27]
    v_perm_b32 v64, v100, v96, s4
    v_perm_b32 v65, v108, v104, s4
    v_mfma_f32_16x16x32_bf16 a[20:23], v[68:71], a[132:135], a[20:23]
    v_perm_b32 v66, v116, v112, s4
    v_subrev_u32 v32, s92, v32
    v_mfma_f32_16x16x32_bf16 a[16:19], v[68:71], a[128:131], a[16:19]
    v_perm_b32 v67, v124, v120, s4
    v_mfma_f32_16x16x32_bf16 a[32:35], v[72:75], a[128:131], a[32:35]
    ds_read_b128 a[148:151], v23
    buffer_load_dwordx4 v[176:179], v5, s[44:47], s7 offen offset:1024
    v_mfma_f32_16x16x32_bf16 a[36:39], v[72:75], a[132:135], a[36:39]
    v_perm_b32 v68, v100, v96, s5
    v_perm_b32 v69, v108, v104, s5
    v_mfma_f32_16x16x32_bf16 a[40:43], v[72:75], a[136:139], a[40:43]
    ds_read_b128 v[20:23], v33 offset:256
    v_perm_b32 v70, v116, v112, s5
    v_mfma_f32_16x16x32_bf16 a[44:47], v[72:75], a[140:143], a[44:47]
    v_perm_b32 v71, v124, v120, s5
    v_mfma_f32_16x16x32_bf16 a[60:63], v[76:79], a[140:143], a[60:63]
    buffer_load_dwordx4 v[180:183], v5, s[44:47], s7 offen offset:1280
    v_mfma_f32_16x16x32_bf16 a[56:59], v[76:79], a[136:139], a[56:59]
    v_perm_b32 v72, v101, v97, s4
    v_subrev_u32 v33, s92, v33
    v_perm_b32 v73, v109, v105, s4
    s_waitcnt lgkmcnt(2)
    v_lshl_add_u32 v16, v16, 4, v6
    v_mfma_f32_16x16x32_bf16 a[52:55], v[76:79], a[132:135], a[52:55]
    ds_read_b128 a[152:155], v27
    v_perm_b32 v74, v117, v113, s4
    v_mfma_f32_16x16x32_bf16 a[48:51], v[76:79], a[128:131], a[48:51]
    v_perm_b32 v75, v125, v121, s4
    v_lshl_add_u32 v17, v17, 4, v6
    v_mfma_f32_16x16x32_bf16 a[64:67], v[80:83], a[128:131], a[64:67]
    ds_read_b128 v[24:27], v34 offset:256
    buffer_load_dwordx4 v[184:187], v5, s[44:47], s7 offen offset:1536
    v_mfma_f32_16x16x32_bf16 a[68:71], v[80:83], a[132:135], a[68:71]
    v_perm_b32 v76, v101, v97, s5
    v_perm_b32 v77, v109, v105, s5
    v_lshl_add_u32 v18, v18, 4, v6
    v_mfma_f32_16x16x32_bf16 a[72:75], v[80:83], a[136:139], a[72:75]
    v_perm_b32 v78, v117, v113, s5
    v_subrev_u32 v34, s92, v34
    v_mfma_f32_16x16x32_bf16 a[76:79], v[80:83], a[140:143], a[76:79]
    v_perm_b32 v79, v125, v121, s5
    v_lshl_add_u32 v19, v19, 4, v6
    s_waitcnt lgkmcnt(2)
    v_lshl_add_u32 v20, v20, 4, v6
    v_mfma_f32_16x16x32_bf16 a[92:95], v[84:87], a[140:143], a[92:95]
    ds_read_b128 a[156:159], v31
    buffer_load_dwordx4 v[188:191], v5, s[44:47], s7 offen offset:1792
    v_mfma_f32_16x16x32_bf16 a[88:91], v[84:87], a[136:139], a[88:91]
    v_perm_b32 v80, v102, v98, s4
    v_perm_b32 v81, v110, v106, s4
    v_lshl_add_u32 v21, v21, 4, v6
    v_mfma_f32_16x16x32_bf16 a[84:87], v[84:87], a[132:135], a[84:87]
    ds_read_b128 v[28:31], v35 offset:256
    v_perm_b32 v82, v118, v114, s4
    v_mfma_f32_16x16x32_bf16 a[80:83], v[84:87], a[128:131], a[80:83]
    v_perm_b32 v83, v126, v122, s4
    v_lshl_add_u32 v22, v22, 4, v6
    v_mfma_f32_16x16x32_bf16 a[96:99], v[88:91], a[128:131], a[96:99]
    s_add_u32 s7, s8, 540672
    buffer_load_dwordx4 v[192:195], v5, s[44:47], s7 offen offset:0
    v_mfma_f32_16x16x32_bf16 a[100:103], v[88:91], a[132:135], a[100:103]
    v_perm_b32 v84, v102, v98, s5
    v_subrev_u32 v35, s92, v35
    v_perm_b32 v85, v110, v106, s5
    v_lshl_add_u32 v23, v23, 4, v6
    s_waitcnt lgkmcnt(2)
    v_lshl_add_u32 v24, v24, 4, v6
    v_mfma_f32_16x16x32_bf16 a[104:107], v[88:91], a[136:139], a[104:107]
    v_perm_b32 v86, v118, v114, s5
    v_mfma_f32_16x16x32_bf16 a[108:111], v[88:91], a[140:143], a[108:111]
    v_perm_b32 v87, v126, v122, s5
    v_lshl_add_u32 v25, v25, 4, v6
    v_mfma_f32_16x16x32_bf16 a[124:127], v[92:95], a[140:143], a[124:127]
    buffer_load_dwordx4 v[196:199], v5, s[44:47], s7 offen offset:256
    v_mfma_f32_16x16x32_bf16 a[120:123], v[92:95], a[136:139], a[120:123]
    v_perm_b32 v88, v103, v99, s4
    v_perm_b32 v89, v111, v107, s4
    v_lshl_add_u32 v26, v26, 4, v6
    v_mfma_f32_16x16x32_bf16 a[116:119], v[92:95], a[132:135], a[116:119]
    v_perm_b32 v90, v119, v115, s4
    v_mfma_f32_16x16x32_bf16 a[112:115], v[92:95], a[128:131], a[112:115]
    buffer_load_dwordx4 v[200:203], v5, s[44:47], s7 offen offset:512
    v_perm_b32 v91, v127, v123, s4
    v_lshl_add_u32 v27, v27, 4, v6
    s_waitcnt lgkmcnt(0)
    v_lshl_add_u32 v28, v28, 4, v6
    v_mfma_f32_16x16x32_bf16 a[0:3], v[64:67], a[144:147], a[0:3]
    v_perm_b32 v92, v103, v99, s5
    v_mfma_f32_16x16x32_bf16 a[4:7], v[64:67], a[148:151], a[4:7]
    v_perm_b32 v93, v111, v107, s5
    v_lshl_add_u32 v29, v29, 4, v6
    v_mfma_f32_16x16x32_bf16 a[8:11], v[64:67], a[152:155], a[8:11]
    ds_read_b128 a[128:131], v16
    v_perm_b32 v94, v119, v115, s5
    v_mfma_f32_16x16x32_bf16 a[12:15], v[64:67], a[156:159], a[12:15]
    buffer_load_dwordx4 v[204:207], v5, s[44:47], s7 offen offset:768
    v_mfma_f32_16x16x32_bf16 a[28:31], v[68:71], a[156:159], a[28:31]
    v_perm_b32 v95, v127, v123, s5
    s_waitcnt vmcnt(12)
    v_lshl_add_u32 v30, v30, 4, v6
    v_perm_b32 v64, v132, v128, s4
    v_mfma_f32_16x16x32_bf16 a[24:27], v[68:71], a[152:155], a[24:27]
    v_perm_b32 v65, v140, v136, s4
    v_lshl_add_u32 v31, v31, 4, v6
    v_mfma_f32_16x16x32_bf16 a[20:23], v[68:71], a[148:151], a[20:23]
    v_perm_b32 v66, v148, v144, s4
    v_mfma_f32_16x16x32_bf16 a[16:19], v[68:71], a[144:147], a[16:19]
    buffer_load_dwordx4 v[208:211], v5, s[44:47], s7 offen offset:1024
    v_perm_b32 v67, v156, v152, s4
    v_mfma_f32_16x16x32_bf16 a[32:35], v[72:75], a[144:147], a[32:35]
    ds_read_b128 a[132:135], v20
    v_perm_b32 v68, v132, v128, s5
    v_mfma_f32_16x16x32_bf16 a[36:39], v[72:75], a[148:151], a[36:39]
    v_perm_b32 v69, v140, v136, s5
    v_mfma_f32_16x16x32_bf16 a[40:43], v[72:75], a[152:155], a[40:43]
    v_perm_b32 v70, v148, v144, s5
    v_mfma_f32_16x16x32_bf16 a[44:47], v[72:75], a[156:159], a[44:47]
    buffer_load_dwordx4 v[212:215], v5, s[44:47], s7 offen offset:1280
    v_mfma_f32_16x16x32_bf16 a[60:63], v[76:79], a[156:159], a[60:63]
    v_perm_b32 v71, v156, v152, s5
    v_perm_b32 v72, v133, v129, s4
    v_mfma_f32_16x16x32_bf16 a[56:59], v[76:79], a[152:155], a[56:59]
    v_perm_b32 v73, v141, v137, s4
    v_mfma_f32_16x16x32_bf16 a[52:55], v[76:79], a[148:151], a[52:55]
    ds_read_b128 a[136:139], v24
    v_perm_b32 v74, v149, v145, s4
    v_mfma_f32_16x16x32_bf16 a[48:51], v[76:79], a[144:147], a[48:51]
    buffer_load_dwordx4 v[216:219], v5, s[44:47], s7 offen offset:1536
    v_mfma_f32_16x16x32_bf16 a[64:67], v[80:83], a[144:147], a[64:67]
    v_perm_b32 v75, v157, v153, s4
    v_perm_b32 v76, v133, v129, s5
    v_mfma_f32_16x16x32_bf16 a[68:71], v[80:83], a[148:151], a[68:71]
    v_perm_b32 v77, v141, v137, s5
    v_mfma_f32_16x16x32_bf16 a[72:75], v[80:83], a[152:155], a[72:75]
    v_perm_b32 v78, v149, v145, s5
    v_mfma_f32_16x16x32_bf16 a[76:79], v[80:83], a[156:159], a[76:79]
    buffer_load_dwordx4 v[220:223], v5, s[44:47], s7 offen offset:1792
    v_perm_b32 v79, v157, v153, s5
    v_mfma_f32_16x16x32_bf16 a[92:95], v[84:87], a[156:159], a[92:95]
    ds_read_b128 a[140:143], v28
    v_perm_b32 v80, v134, v130, s4
    v_mfma_f32_16x16x32_bf16 a[88:91], v[84:87], a[152:155], a[88:91]
    v_perm_b32 v81, v142, v138, s4
    v_mfma_f32_16x16x32_bf16 a[84:87], v[84:87], a[148:151], a[84:87]
    s_add_u32 s7, s8, 548864
    buffer_load_dwordx4 v[224:227], v5, s[44:47], s7 offen offset:0
    v_mfma_f32_16x16x32_bf16 a[80:83], v[84:87], a[144:147], a[80:83]
    v_perm_b32 v82, v150, v146, s4
    v_perm_b32 v83, v158, v154, s4
    v_mfma_f32_16x16x32_bf16 a[96:99], v[88:91], a[144:147], a[96:99]
    v_perm_b32 v84, v134, v130, s5
    v_mfma_f32_16x16x32_bf16 a[100:103], v[88:91], a[148:151], a[100:103]
    v_perm_b32 v85, v142, v138, s5
    v_mfma_f32_16x16x32_bf16 a[104:107], v[88:91], a[152:155], a[104:107]
    buffer_load_dwordx4 v[228:231], v5, s[44:47], s7 offen offset:256
    v_mfma_f32_16x16x32_bf16 a[108:111], v[88:91], a[156:159], a[108:111]
    v_perm_b32 v86, v150, v146, s5
    v_perm_b32 v87, v158, v154, s5
    v_mfma_f32_16x16x32_bf16 a[124:127], v[92:95], a[156:159], a[124:127]
    v_perm_b32 v88, v135, v131, s4
    v_mfma_f32_16x16x32_bf16 a[120:123], v[92:95], a[152:155], a[120:123]
    v_perm_b32 v89, v143, v139, s4
    v_mfma_f32_16x16x32_bf16 a[116:119], v[92:95], a[148:151], a[116:119]
    buffer_load_dwordx4 v[232:235], v5, s[44:47], s7 offen offset:512
    v_mfma_f32_16x16x32_bf16 a[112:115], v[92:95], a[144:147], a[112:115]
    v_perm_b32 v90, v151, v147, s4
    v_perm_b32 v91, v159, v155, s4
    s_waitcnt lgkmcnt(3)
    v_mfma_f32_16x16x32_bf16 a[0:3], v[64:67], a[128:131], a[0:3]
    v_perm_b32 v92, v135, v131, s5
    s_waitcnt lgkmcnt(2)
    v_mfma_f32_16x16x32_bf16 a[4:7], v[64:67], a[132:135], a[4:7]
    v_perm_b32 v93, v143, v139, s5
    s_waitcnt lgkmcnt(1)
    v_mfma_f32_16x16x32_bf16 a[8:11], v[64:67], a[136:139], a[8:11]
    ds_read_b128 a[144:147], v17
    buffer_load_dwordx4 v[236:239], v5, s[44:47], s7 offen offset:768
    s_waitcnt lgkmcnt(1)
    v_mfma_f32_16x16x32_bf16 a[12:15], v[64:67], a[140:143], a[12:15]
    v_perm_b32 v94, v151, v147, s5
    v_perm_b32 v95, v159, v155, s5
    s_waitcnt vmcnt(12)
    v_mfma_f32_16x16x32_bf16 a[28:31], v[68:71], a[140:143], a[28:31]
    v_perm_b32 v64, v164, v160, s4
    v_mfma_f32_16x16x32_bf16 a[24:27], v[68:71], a[136:139], a[24:27]
    v_perm_b32 v65, v172, v168, s4
    v_mfma_f32_16x16x32_bf16 a[20:23], v[68:71], a[132:135], a[20:23]
    buffer_load_dwordx4 v[240:243], v5, s[44:47], s7 offen offset:1024
    v_mfma_f32_16x16x32_bf16 a[16:19], v[68:71], a[128:131], a[16:19]
    v_perm_b32 v66, v180, v176, s4
    v_perm_b32 v67, v188, v184, s4
    v_mfma_f32_16x16x32_bf16 a[32:35], v[72:75], a[128:131], a[32:35]
    ds_read_b128 a[148:151], v21
    v_perm_b32 v68, v164, v160, s5
    v_mfma_f32_16x16x32_bf16 a[36:39], v[72:75], a[132:135], a[36:39]
    v_perm_b32 v69, v172, v168, s5
    v_mfma_f32_16x16x32_bf16 a[40:43], v[72:75], a[136:139], a[40:43]
    buffer_load_dwordx4 v[244:247], v5, s[44:47], s7 offen offset:1280
    v_mfma_f32_16x16x32_bf16 a[44:47], v[72:75], a[140:143], a[44:47]
    v_perm_b32 v70, v180, v176, s5
    v_perm_b32 v71, v188, v184, s5
    v_mfma_f32_16x16x32_bf16 a[60:63], v[76:79], a[140:143], a[60:63]
    v_perm_b32 v72, v165, v161, s4
    v_mfma_f32_16x16x32_bf16 a[56:59], v[76:79], a[136:139], a[56:59]
    v_perm_b32 v73, v173, v169, s4
    v_mfma_f32_16x16x32_bf16 a[52:55], v[76:79], a[132:135], a[52:55]
    ds_read_b128 a[152:155], v25
    buffer_load_dwordx4 v[248:251], v5, s[44:47], s7 offen offset:1536
    v_mfma_f32_16x16x32_bf16 a[48:51], v[76:79], a[128:131], a[48:51]
    v_perm_b32 v74, v181, v177, s4
    v_perm_b32 v75, v189, v185, s4
    v_mfma_f32_16x16x32_bf16 a[64:67], v[80:83], a[128:131], a[64:67]
    v_perm_b32 v76, v165, v161, s5
    v_mfma_f32_16x16x32_bf16 a[68:71], v[80:83], a[132:135], a[68:71]
    buffer_load_dwordx4 v[252:255], v5, s[44:47], s7 offen offset:1792
    v_mfma_f32_16x16x32_bf16 a[72:75], v[80:83], a[136:139], a[72:75]
    v_perm_b32 v77, v173, v169, s5
    v_perm_b32 v78, v181, v177, s5
    v_mfma_f32_16x16x32_bf16 a[76:79], v[80:83], a[140:143], a[76:79]
    v_perm_b32 v79, v189, v185, s5
    v_mfma_f32_16x16x32_bf16 a[92:95], v[84:87], a[140:143], a[92:95]
    ds_read_b128 a[156:159], v29
    v_perm_b32 v80, v166, v162, s4
    v_mfma_f32_16x16x32_bf16 a[88:91], v[84:87], a[136:139], a[88:91]
    s_add_u32 s7, s83, 655360
    buffer_load_dwordx4 v[96:99], v5, s[44:47], s7 offen offset:0
    v_mfma_f32_16x16x32_bf16 a[84:87], v[84:87], a[132:135], a[84:87]
    v_perm_b32 v81, v174, v170, s4
    v_perm_b32 v82, v182, v178, s4
    v_mfma_f32_16x16x32_bf16 a[80:83], v[84:87], a[128:131], a[80:83]
    v_perm_b32 v83, v190, v186, s4
    v_mfma_f32_16x16x32_bf16 a[96:99], v[88:91], a[128:131], a[96:99]
    v_perm_b32 v84, v166, v162, s5
    v_mfma_f32_16x16x32_bf16 a[100:103], v[88:91], a[132:135], a[100:103]
    buffer_load_dwordx4 v[100:103], v5, s[44:47], s7 offen offset:256
    v_mfma_f32_16x16x32_bf16 a[104:107], v[88:91], a[136:139], a[104:107]
    v_perm_b32 v85, v174, v170, s5
    v_perm_b32 v86, v182, v178, s5
    v_mfma_f32_16x16x32_bf16 a[108:111], v[88:91], a[140:143], a[108:111]
    v_perm_b32 v87, v190, v186, s5
    v_mfma_f32_16x16x32_bf16 a[124:127], v[92:95], a[140:143], a[124:127]
    v_perm_b32 v88, v167, v163, s4
    v_mfma_f32_16x16x32_bf16 a[120:123], v[92:95], a[136:139], a[120:123]
    buffer_load_dwordx4 v[104:107], v5, s[44:47], s7 offen offset:512
    v_mfma_f32_16x16x32_bf16 a[116:119], v[92:95], a[132:135], a[116:119]
    v_perm_b32 v89, v175, v171, s4
    v_perm_b32 v90, v183, v179, s4
    v_mfma_f32_16x16x32_bf16 a[112:115], v[92:95], a[128:131], a[112:115]
    v_perm_b32 v91, v191, v187, s4
    s_waitcnt lgkmcnt(3)
    v_mfma_f32_16x16x32_bf16 a[0:3], v[64:67], a[144:147], a[0:3]
    v_perm_b32 v92, v167, v163, s5
    s_waitcnt lgkmcnt(2)
    v_mfma_f32_16x16x32_bf16 a[4:7], v[64:67], a[148:151], a[4:7]
    buffer_load_dwordx4 v[108:111], v5, s[44:47], s7 offen offset:768
    v_perm_b32 v93, v175, v171, s5
    s_waitcnt lgkmcnt(1)
    v_mfma_f32_16x16x32_bf16 a[8:11], v[64:67], a[152:155], a[8:11]
    ds_read_b128 a[128:131], v18
    v_perm_b32 v94, v183, v179, s5
    s_waitcnt lgkmcnt(1)
    v_mfma_f32_16x16x32_bf16 a[12:15], v[64:67], a[156:159], a[12:15]
    v_perm_b32 v95, v191, v187, s5
    s_waitcnt vmcnt(12)
    v_mfma_f32_16x16x32_bf16 a[28:31], v[68:71], a[156:159], a[28:31]
    v_perm_b32 v64, v196, v192, s4
    v_mfma_f32_16x16x32_bf16 a[24:27], v[68:71], a[152:155], a[24:27]
    buffer_load_dwordx4 v[112:115], v5, s[44:47], s7 offen offset:1024
    v_mfma_f32_16x16x32_bf16 a[20:23], v[68:71], a[148:151], a[20:23]
    v_perm_b32 v65, v204, v200, s4
    v_perm_b32 v66, v212, v208, s4
    v_mfma_f32_16x16x32_bf16 a[16:19], v[68:71], a[144:147], a[16:19]
    v_perm_b32 v67, v220, v216, s4
    v_mfma_f32_16x16x32_bf16 a[32:35], v[72:75], a[144:147], a[32:35]
    ds_read_b128 a[132:135], v22
    v_perm_b32 v68, v196, v192, s5
    v_mfma_f32_16x16x32_bf16 a[36:39], v[72:75], a[148:151], a[36:39]
    buffer_load_dwordx4 v[116:119], v5, s[44:47], s7 offen offset:1280
    v_mfma_f32_16x16x32_bf16 a[40:43], v[72:75], a[152:155], a[40:43]
    v_perm_b32 v69, v204, v200, s5
    v_perm_b32 v70, v212, v208, s5
    v_mfma_f32_16x16x32_bf16 a[44:47], v[72:75], a[156:159], a[44:47]
    v_perm_b32 v71, v220, v216, s5
    v_mfma_f32_16x16x32_bf16 a[60:63], v[76:79], a[156:159], a[60:63]
    buffer_load_dwordx4 v[120:123], v5, s[44:47], s7 offen offset:1536
    v_mfma_f32_16x16x32_bf16 a[56:59], v[76:79], a[152:155], a[56:59]
    v_perm_b32 v72, v197, v193, s4
    v_perm_b32 v73, v205, v201, s4
    v_mfma_f32_16x16x32_bf16 a[52:55], v[76:79], a[148:151], a[52:55]
    ds_read_b128 a[136:139], v26
    v_perm_b32 v74, v213, v209, s4
    v_mfma_f32_16x16x32_bf16 a[48:51], v[76:79], a[144:147], a[48:51]
    v_perm_b32 v75, v221, v217, s4
    v_mfma_f32_16x16x32_bf16 a[64:67], v[80:83], a[144:147], a[64:67]
    buffer_load_dwordx4 v[124:127], v5, s[44:47], s7 offen offset:1792
    v_mfma_f32_16x16x32_bf16 a[68:71], v[80:83], a[148:151], a[68:71]
    v_perm_b32 v76, v197, v193, s5
    v_perm_b32 v77, v205, v201, s5
    v_mfma_f32_16x16x32_bf16 a[72:75], v[80:83], a[152:155], a[72:75]
    v_perm_b32 v78, v213, v209, s5
    v_mfma_f32_16x16x32_bf16 a[76:79], v[80:83], a[156:159], a[76:79]
    v_perm_b32 v79, v221, v217, s5
    v_mfma_f32_16x16x32_bf16 a[92:95], v[84:87], a[156:159], a[92:95]
    ds_read_b128 a[140:143], v30
    s_add_u32 s7, s83, 663552
    buffer_load_dwordx4 v[128:131], v5, s[44:47], s7 offen offset:0
    v_mfma_f32_16x16x32_bf16 a[88:91], v[84:87], a[152:155], a[88:91]
    v_perm_b32 v80, v198, v194, s4
    v_perm_b32 v81, v206, v202, s4
    v_mfma_f32_16x16x32_bf16 a[84:87], v[84:87], a[148:151], a[84:87]
    v_perm_b32 v82, v214, v210, s4
    v_mfma_f32_16x16x32_bf16 a[80:83], v[84:87], a[144:147], a[80:83]
    v_perm_b32 v83, v222, v218, s4
    v_mfma_f32_16x16x32_bf16 a[96:99], v[88:91], a[144:147], a[96:99]
    buffer_load_dwordx4 v[132:135], v5, s[44:47], s7 offen offset:256
    v_mfma_f32_16x16x32_bf16 a[100:103], v[88:91], a[148:151], a[100:103]
    v_perm_b32 v84, v198, v194, s5
    v_perm_b32 v85, v206, v202, s5
    v_mfma_f32_16x16x32_bf16 a[104:107], v[88:91], a[152:155], a[104:107]
    v_perm_b32 v86, v214, v210, s5
    v_mfma_f32_16x16x32_bf16 a[108:111], v[88:91], a[156:159], a[108:111]
    v_perm_b32 v87, v222, v218, s5
    v_mfma_f32_16x16x32_bf16 a[124:127], v[92:95], a[156:159], a[124:127]
    buffer_load_dwordx4 v[136:139], v5, s[44:47], s7 offen offset:512
    v_mfma_f32_16x16x32_bf16 a[120:123], v[92:95], a[152:155], a[120:123]
    v_perm_b32 v88, v199, v195, s4
    v_perm_b32 v89, v207, v203, s4
    v_mfma_f32_16x16x32_bf16 a[116:119], v[92:95], a[148:151], a[116:119]
    v_perm_b32 v90, v215, v211, s4
    v_mfma_f32_16x16x32_bf16 a[112:115], v[92:95], a[144:147], a[112:115]
    v_perm_b32 v91, v223, v219, s4
    s_waitcnt lgkmcnt(3)
    v_mfma_f32_16x16x32_bf16 a[0:3], v[64:67], a[128:131], a[0:3]
    buffer_load_dwordx4 v[140:143], v5, s[44:47], s7 offen offset:768
    s_waitcnt lgkmcnt(2)
    v_mfma_f32_16x16x32_bf16 a[4:7], v[64:67], a[132:135], a[4:7]
    v_perm_b32 v92, v199, v195, s5
    v_perm_b32 v93, v207, v203, s5
    s_waitcnt lgkmcnt(1)
    v_mfma_f32_16x16x32_bf16 a[8:11], v[64:67], a[136:139], a[8:11]
    ds_read_b128 a[144:147], v19
    v_perm_b32 v94, v215, v211, s5
    s_waitcnt lgkmcnt(1)
    v_mfma_f32_16x16x32_bf16 a[12:15], v[64:67], a[140:143], a[12:15]
    buffer_load_dwordx4 v[144:147], v5, s[44:47], s7 offen offset:1024
    v_perm_b32 v95, v223, v219, s5
    s_waitcnt vmcnt(13)
    v_mfma_f32_16x16x32_bf16 a[28:31], v[68:71], a[140:143], a[28:31]
    ds_read_b128 v[16:19], v32 offset:320
    v_perm_b32 v64, v228, v224, s4
    v_mfma_f32_16x16x32_bf16 a[24:27], v[68:71], a[136:139], a[24:27]
    v_perm_b32 v65, v236, v232, s4
    v_mfma_f32_16x16x32_bf16 a[20:23], v[68:71], a[132:135], a[20:23]
    v_perm_b32 v66, v244, v240, s4
    v_mfma_f32_16x16x32_bf16 a[16:19], v[68:71], a[128:131], a[16:19]
    buffer_load_dwordx4 v[148:151], v5, s[44:47], s7 offen offset:1280
    v_perm_b32 v67, v252, v248, s4
    v_mfma_f32_16x16x32_bf16 a[32:35], v[72:75], a[128:131], a[32:35]
    ds_read_b128 a[148:151], v23
    v_perm_b32 v68, v228, v224, s5
    v_mfma_f32_16x16x32_bf16 a[36:39], v[72:75], a[132:135], a[36:39]
    v_perm_b32 v69, v236, v232, s5
    v_mfma_f32_16x16x32_bf16 a[40:43], v[72:75], a[136:139], a[40:43]
    ds_read_b128 v[20:23], v33 offset:320
    v_perm_b32 v70, v244, v240, s5
    v_mfma_f32_16x16x32_bf16 a[44:47], v[72:75], a[140:143], a[44:47]
    buffer_load_dwordx4 v[152:155], v5, s[44:47], s7 offen offset:1536
    v_mfma_f32_16x16x32_bf16 a[60:63], v[76:79], a[140:143], a[60:63]
    v_perm_b32 v71, v252, v248, s5
    v_perm_b32 v72, v229, v225, s4
    v_mfma_f32_16x16x32_bf16 a[56:59], v[76:79], a[136:139], a[56:59]
    v_perm_b32 v73, v237, v233, s4
    s_waitcnt lgkmcnt(2)
    v_lshl_add_u32 v16, v16, 4, v6
    v_mfma_f32_16x16x32_bf16 a[52:55], v[76:79], a[132:135], a[52:55]
    ds_read_b128 a[152:155], v27
    v_perm_b32 v74, v245, v241, s4
    v_mfma_f32_16x16x32_bf16 a[48:51], v[76:79], a[128:131], a[48:51]
    buffer_load_dwordx4 v[156:159], v5, s[44:47], s7 offen offset:1792
    v_perm_b32 v75, v253, v249, s4
    v_lshl_add_u32 v17, v17, 4, v6
    v_mfma_f32_16x16x32_bf16 a[64:67], v[80:83], a[128:131], a[64:67]
    ds_read_b128 v[24:27], v34 offset:320
    v_perm_b32 v76, v229, v225, s5
    v_mfma_f32_16x16x32_bf16 a[68:71], v[80:83], a[132:135], a[68:71]
    v_perm_b32 v77, v237, v233, s5
    v_lshl_add_u32 v18, v18, 4, v6
    v_mfma_f32_16x16x32_bf16 a[72:75], v[80:83], a[136:139], a[72:75]
    v_perm_b32 v78, v245, v241, s5
    v_mfma_f32_16x16x32_bf16 a[76:79], v[80:83], a[140:143], a[76:79]
    s_add_u32 s7, s83, 671744
    buffer_load_dwordx4 v[160:163], v5, s[44:47], s7 offen offset:0
    v_perm_b32 v79, v253, v249, s5
    v_lshl_add_u32 v19, v19, 4, v6
    s_waitcnt lgkmcnt(2)
    v_lshl_add_u32 v20, v20, 4, v6
    v_mfma_f32_16x16x32_bf16 a[92:95], v[84:87], a[140:143], a[92:95]
    ds_read_b128 a[156:159], v31
    v_perm_b32 v80, v230, v226, s4
    v_mfma_f32_16x16x32_bf16 a[88:91], v[84:87], a[136:139], a[88:91]
    v_perm_b32 v81, v238, v234, s4
    v_lshl_add_u32 v21, v21, 4, v6
    v_mfma_f32_16x16x32_bf16 a[84:87], v[84:87], a[132:135], a[84:87]
    ds_read_b128 v[28:31], v35 offset:320
    v_perm_b32 v82, v246, v242, s4
    v_mfma_f32_16x16x32_bf16 a[80:83], v[84:87], a[128:131], a[80:83]
    buffer_load_dwordx4 v[164:167], v5, s[44:47], s7 offen offset:256
    v_mfma_f32_16x16x32_bf16 a[96:99], v[88:91], a[128:131], a[96:99]
    v_perm_b32 v83, v254, v250, s4
    v_lshl_add_u32 v22, v22, 4, v6
    v_perm_b32 v84, v230, v226, s5
    v_mfma_f32_16x16x32_bf16 a[100:103], v[88:91], a[132:135], a[100:103]
    v_perm_b32 v85, v238, v234, s5
    v_lshl_add_u32 v23, v23, 4, v6
    s_waitcnt lgkmcnt(2)
    v_lshl_add_u32 v24, v24, 4, v6
    v_mfma_f32_16x16x32_bf16 a[104:107], v[88:91], a[136:139], a[104:107]
    v_perm_b32 v86, v246, v242, s5
    v_mfma_f32_16x16x32_bf16 a[108:111], v[88:91], a[140:143], a[108:111]
    buffer_load_dwordx4 v[168:171], v5, s[44:47], s7 offen offset:512
    v_mfma_f32_16x16x32_bf16 a[124:127], v[92:95], a[140:143], a[124:127]
    v_perm_b32 v87, v254, v250, s5
    v_lshl_add_u32 v25, v25, 4, v6
    v_perm_b32 v88, v231, v227, s4
    v_mfma_f32_16x16x32_bf16 a[120:123], v[92:95], a[136:139], a[120:123]
    v_perm_b32 v89, v239, v235, s4
    v_lshl_add_u32 v26, v26, 4, v6
    v_mfma_f32_16x16x32_bf16 a[116:119], v[92:95], a[132:135], a[116:119]
    buffer_load_dwordx4 v[172:175], v5, s[44:47], s7 offen offset:768
    v_mfma_f32_16x16x32_bf16 a[112:115], v[92:95], a[128:131], a[112:115]
    v_perm_b32 v90, v247, v243, s4
    v_perm_b32 v91, v255, v251, s4
    v_lshl_add_u32 v27, v27, 4, v6
    s_waitcnt lgkmcnt(0)
    v_lshl_add_u32 v28, v28, 4, v6
    v_mfma_f32_16x16x32_bf16 a[0:3], v[64:67], a[144:147], a[0:3]
    v_perm_b32 v92, v231, v227, s5
    v_mfma_f32_16x16x32_bf16 a[4:7], v[64:67], a[148:151], a[4:7]
    v_perm_b32 v93, v239, v235, s5
    v_lshl_add_u32 v29, v29, 4, v6
    v_mfma_f32_16x16x32_bf16 a[8:11], v[64:67], a[152:155], a[8:11]
    ds_read_b128 a[128:131], v16
    buffer_load_dwordx4 v[176:179], v5, s[44:47], s7 offen offset:1024
    v_mfma_f32_16x16x32_bf16 a[12:15], v[64:67], a[156:159], a[12:15]
    v_perm_b32 v94, v247, v243, s5
    v_perm_b32 v95, v255, v251, s5
    s_waitcnt vmcnt(13)
    v_lshl_add_u32 v30, v30, 4, v6
    s_mul_i32 s12, s3, 12
    s_lshr_b32 s13, s92, 1
    s_sub_u32 s12, s12, s13
    v_subrev_u32 v32, s12, v32
    v_mfma_f32_16x16x32_bf16 a[28:31], v[68:71], a[156:159], a[28:31]
    v_perm_b32 v64, v100, v96, s4
    v_mfma_f32_16x16x32_bf16 a[24:27], v[68:71], a[152:155], a[24:27]
    ds_read_b32 v36, v32 offset:384
    v_perm_b32 v65, v108, v104, s4
    v_lshl_add_u32 v31, v31, 4, v6
    v_mfma_f32_16x16x32_bf16 a[20:23], v[68:71], a[148:151], a[20:23]
    buffer_load_dwordx4 v[180:183], v5, s[44:47], s7 offen offset:1280
    v_mfma_f32_16x16x32_bf16 a[16:19], v[68:71], a[144:147], a[16:19]
    v_perm_b32 v66, v116, v112, s4
    v_perm_b32 v67, v124, v120, s4
    v_mfma_f32_16x16x32_bf16 a[32:35], v[72:75], a[144:147], a[32:35]
    ds_read_b128 a[132:135], v20
    v_perm_b32 v68, v100, v96, s5
    v_mfma_f32_16x16x32_bf16 a[36:39], v[72:75], a[148:151], a[36:39]
    v_perm_b32 v69, v108, v104, s5
    s_mul_i32 s12, s3, 12
    s_lshr_b32 s13, s92, 1
    s_sub_u32 s12, s12, s13
    v_subrev_u32 v33, s12, v33
    v_mfma_f32_16x16x32_bf16 a[40:43], v[72:75], a[152:155], a[40:43]
    buffer_load_dwordx4 v[184:187], v5, s[44:47], s7 offen offset:1536
    v_perm_b32 v70, v116, v112, s5
    v_mfma_f32_16x16x32_bf16 a[44:47], v[72:75], a[156:159], a[44:47]
    ds_read_b32 v37, v33 offset:384
    v_perm_b32 v71, v124, v120, s5
    v_mfma_f32_16x16x32_bf16 a[60:63], v[76:79], a[156:159], a[60:63]
    v_perm_b32 v72, v101, v97, s4
    v_mfma_f32_16x16x32_bf16 a[56:59], v[76:79], a[152:155], a[56:59]
    v_perm_b32 v73, v109, v105, s4
    s_waitcnt lgkmcnt(2)
    v_lshl_add_u32 v36, v36, 4, v6
    v_mfma_f32_16x16x32_bf16 a[52:55], v[76:79], a[148:151], a[52:55]
    ds_read_b128 a[136:139], v24
    buffer_load_dwordx4 v[188:191], v5, s[44:47], s7 offen offset:1792
    v_mfma_f32_16x16x32_bf16 a[48:51], v[76:79], a[144:147], a[48:51]
    v_perm_b32 v74, v117, v113, s4
    v_perm_b32 v75, v125, v121, s4
    s_mul_i32 s12, s3, 12
    s_lshr_b32 s13, s92, 1
    s_sub_u32 s12, s12, s13
    v_subrev_u32 v34, s12, v34
    v_mfma_f32_16x16x32_bf16 a[64:67], v[80:83], a[144:147], a[64:67]
    v_perm_b32 v76, v101, v97, s5
    v_mfma_f32_16x16x32_bf16 a[68:71], v[80:83], a[148:151], a[68:71]
    ds_read_b32 v38, v34 offset:384
    v_perm_b32 v77, v109, v105, s5
    v_mfma_f32_16x16x32_bf16 a[72:75], v[80:83], a[152:155], a[72:75]
    s_add_u32 s7, s83, 679936
    buffer_load_dwordx4 v[192:195], v5, s[44:47], s7 offen offset:0
    v_mfma_f32_16x16x32_bf16 a[76:79], v[80:83], a[156:159], a[76:79]
    v_perm_b32 v78, v117, v113, s5
    v_perm_b32 v79, v125, v121, s5
    s_waitcnt lgkmcnt(2)
    v_lshl_add_u32 v37, v37, 4, v6
    v_mfma_f32_16x16x32_bf16 a[92:95], v[84:87], a[156:159], a[92:95]
    ds_read_b128 a[140:143], v28
    v_perm_b32 v80, v102, v98, s4
    v_mfma_f32_16x16x32_bf16 a[88:91], v[84:87], a[152:155], a[88:91]
    v_perm_b32 v81, v110, v106, s4
    s_mul_i32 s12, s3, 12
    s_lshr_b32 s13, s92, 1
    s_sub_u32 s12, s12, s13
    v_subrev_u32 v35, s12, v35
    v_mfma_f32_16x16x32_bf16 a[84:87], v[84:87], a[148:151], a[84:87]
    buffer_load_dwordx4 v[196:199], v5, s[44:47], s7 offen offset:256
    v_perm_b32 v82, v118, v114, s4
    v_mfma_f32_16x16x32_bf16 a[80:83], v[84:87], a[144:147], a[80:83]
    ds_read_b32 v39, v35 offset:384
    v_perm_b32 v83, v126, v122, s4
    v_mfma_f32_16x16x32_bf16 a[96:99], v[88:91], a[144:147], a[96:99]
    v_perm_b32 v84, v102, v98, s5
    v_mfma_f32_16x16x32_bf16 a[100:103], v[88:91], a[148:151], a[100:103]
    buffer_load_dwordx4 v[200:203], v5, s[44:47], s7 offen offset:512
    v_mfma_f32_16x16x32_bf16 a[104:107], v[88:91], a[152:155], a[104:107]
    v_perm_b32 v85, v110, v106, s5
    s_waitcnt lgkmcnt(2)
    v_lshl_add_u32 v38, v38, 4, v6
    v_perm_b32 v86, v118, v114, s5
    v_mfma_f32_16x16x32_bf16 a[108:111], v[88:91], a[156:159], a[108:111]
    v_perm_b32 v87, v126, v122, s5
    v_mfma_f32_16x16x32_bf16 a[124:127], v[92:95], a[156:159], a[124:127]
    v_perm_b32 v88, v103, v99, s4
    v_mfma_f32_16x16x32_bf16 a[120:123], v[92:95], a[152:155], a[120:123]
    buffer_load_dwordx4 v[204:207], v5, s[44:47], s7 offen offset:768
    v_mfma_f32_16x16x32_bf16 a[116:119], v[92:95], a[148:151], a[116:119]
    v_perm_b32 v89, v111, v107, s4
    v_perm_b32 v90, v119, v115, s4
    v_mfma_f32_16x16x32_bf16 a[112:115], v[92:95], a[144:147], a[112:115]
    v_perm_b32 v91, v127, v123, s4
    s_waitcnt lgkmcnt(0)
    v_lshl_add_u32 v39, v39, 4, v6
    v_mfma_f32_16x16x32_bf16 a[0:3], v[64:67], a[128:131], a[0:3]
    v_perm_b32 v92, v103, v99, s5
    v_mfma_f32_16x16x32_bf16 a[4:7], v[64:67], a[132:135], a[4:7]
    buffer_load_dwordx4 v[208:211], v5, s[44:47], s7 offen offset:1024
    v_perm_b32 v93, v111, v107, s5
    v_mfma_f32_16x16x32_bf16 a[8:11], v[64:67], a[136:139], a[8:11]
    ds_read_b128 a[144:147], v17
    v_perm_b32 v94, v119, v115, s5
    v_mfma_f32_16x16x32_bf16 a[12:15], v[64:67], a[140:143], a[12:15]
    v_perm_b32 v95, v127, v123, s5
    s_waitcnt vmcnt(13)
    v_mfma_f32_16x16x32_bf16 a[28:31], v[68:71], a[140:143], a[28:31]
    v_perm_b32 v64, v132, v128, s4
    v_mfma_f32_16x16x32_bf16 a[24:27], v[68:71], a[136:139], a[24:27]
    buffer_load_dwordx4 v[212:215], v5, s[44:47], s7 offen offset:1280
    v_mfma_f32_16x16x32_bf16 a[20:23], v[68:71], a[132:135], a[20:23]
    v_perm_b32 v65, v140, v136, s4
    v_perm_b32 v66, v148, v144, s4
    v_mfma_f32_16x16x32_bf16 a[16:19], v[68:71], a[128:131], a[16:19]
    v_perm_b32 v67, v156, v152, s4
    v_mfma_f32_16x16x32_bf16 a[32:35], v[72:75], a[128:131], a[32:35]
    ds_read_b128 a[148:151], v21
    v_perm_b32 v68, v132, v128, s5
    s_barrier
    v_mfma_f32_16x16x32_bf16 a[36:39], v[72:75], a[132:135], a[36:39]
    buffer_load_dwordx4 v[216:219], v5, s[44:47], s7 offen offset:1536
    v_mfma_f32_16x16x32_bf16 a[40:43], v[72:75], a[136:139], a[40:43]
    v_perm_b32 v69, v140, v136, s5
    v_perm_b32 v70, v148, v144, s5
    v_mfma_f32_16x16x32_bf16 a[44:47], v[72:75], a[140:143], a[44:47]
    v_perm_b32 v71, v156, v152, s5
    v_mfma_f32_16x16x32_bf16 a[60:63], v[76:79], a[140:143], a[60:63]
    v_perm_b32 v72, v133, v129, s4
    v_mfma_f32_16x16x32_bf16 a[56:59], v[76:79], a[136:139], a[56:59]
    buffer_load_dwordx4 v[220:223], v5, s[44:47], s7 offen offset:1792
    v_perm_b32 v73, v141, v137, s4
    v_mfma_f32_16x16x32_bf16 a[52:55], v[76:79], a[132:135], a[52:55]
    ds_read_b128 a[152:155], v25
    v_perm_b32 v74, v149, v145, s4
    v_mfma_f32_16x16x32_bf16 a[48:51], v[76:79], a[128:131], a[48:51]
    v_perm_b32 v75, v157, v153, s4
    v_mfma_f32_16x16x32_bf16 a[64:67], v[80:83], a[128:131], a[64:67]
    s_mov_b32 s7, s15
    buffer_load_dwordx4 v[224:227], v5, s[44:47], s7 offen offset:0
    v_mfma_f32_16x16x32_bf16 a[68:71], v[80:83], a[132:135], a[68:71]
    v_perm_b32 v76, v133, v129, s5
    v_perm_b32 v77, v141, v137, s5
    v_mfma_f32_16x16x32_bf16 a[72:75], v[80:83], a[136:139], a[72:75]
    v_perm_b32 v78, v149, v145, s5
    v_mfma_f32_16x16x32_bf16 a[76:79], v[80:83], a[140:143], a[76:79]
    v_perm_b32 v79, v157, v153, s5
    v_mfma_f32_16x16x32_bf16 a[92:95], v[84:87], a[140:143], a[92:95]
    ds_read_b128 a[156:159], v29
    buffer_load_dwordx4 v[228:231], v5, s[44:47], s7 offen offset:256
    v_mfma_f32_16x16x32_bf16 a[88:91], v[84:87], a[136:139], a[88:91]
    v_perm_b32 v80, v134, v130, s4
    v_perm_b32 v81, v142, v138, s4
    v_mfma_f32_16x16x32_bf16 a[84:87], v[84:87], a[132:135], a[84:87]
    v_perm_b32 v82, v150, v146, s4
    v_mfma_f32_16x16x32_bf16 a[80:83], v[84:87], a[128:131], a[80:83]
    v_perm_b32 v83, v158, v154, s4
    v_mfma_f32_16x16x32_bf16 a[96:99], v[88:91], a[128:131], a[96:99]
    buffer_load_dwordx4 v[232:235], v5, s[44:47], s7 offen offset:512
    v_mfma_f32_16x16x32_bf16 a[100:103], v[88:91], a[132:135], a[100:103]
    v_perm_b32 v84, v134, v130, s5
    v_perm_b32 v85, v142, v138, s5
    v_mfma_f32_16x16x32_bf16 a[104:107], v[88:91], a[136:139], a[104:107]
    v_perm_b32 v86, v150, v146, s5
    v_mfma_f32_16x16x32_bf16 a[108:111], v[88:91], a[140:143], a[108:111]
    v_perm_b32 v87, v158, v154, s5
    v_mfma_f32_16x16x32_bf16 a[124:127], v[92:95], a[140:143], a[124:127]
    buffer_load_dwordx4 v[236:239], v5, s[44:47], s7 offen offset:768
    v_mfma_f32_16x16x32_bf16 a[120:123], v[92:95], a[136:139], a[120:123]
    v_perm_b32 v88, v135, v131, s4
    v_perm_b32 v89, v143, v139, s4
    v_mfma_f32_16x16x32_bf16 a[116:119], v[92:95], a[132:135], a[116:119]
    v_perm_b32 v90, v151, v147, s4
    v_mfma_f32_16x16x32_bf16 a[112:115], v[92:95], a[128:131], a[112:115]
    v_perm_b32 v91, v159, v155, s4
    s_waitcnt lgkmcnt(3)
    v_mfma_f32_16x16x32_bf16 a[0:3], v[64:67], a[144:147], a[0:3]
    buffer_load_dwordx4 v[240:243], v5, s[44:47], s7 offen offset:1024
    s_waitcnt lgkmcnt(2)
    v_mfma_f32_16x16x32_bf16 a[4:7], v[64:67], a[148:151], a[4:7]
    v_perm_b32 v92, v135, v131, s5
    v_perm_b32 v93, v143, v139, s5
    s_waitcnt lgkmcnt(1)
    v_mfma_f32_16x16x32_bf16 a[8:11], v[64:67], a[152:155], a[8:11]
    ds_read_b128 a[128:131], v18
    v_perm_b32 v94, v151, v147, s5
    s_waitcnt lgkmcnt(1)
    v_mfma_f32_16x16x32_bf16 a[12:15], v[64:67], a[156:159], a[12:15]
    v_perm_b32 v95, v159, v155, s5
    s_waitcnt vmcnt(13)
    v_mfma_f32_16x16x32_bf16 a[28:31], v[68:71], a[156:159], a[28:31]
    buffer_load_dwordx4 v[244:247], v5, s[44:47], s7 offen offset:1280
    v_mfma_f32_16x16x32_bf16 a[24:27], v[68:71], a[152:155], a[24:27]
    v_perm_b32 v64, v164, v160, s4
    v_perm_b32 v65, v172, v168, s4
    v_mfma_f32_16x16x32_bf16 a[20:23], v[68:71], a[148:151], a[20:23]
    v_perm_b32 v66, v180, v176, s4
    v_mfma_f32_16x16x32_bf16 a[16:19], v[68:71], a[144:147], a[16:19]
    v_perm_b32 v67, v188, v184, s4
    v_mfma_f32_16x16x32_bf16 a[32:35], v[72:75], a[144:147], a[32:35]
    ds_read_b128 a[132:135], v22
    buffer_load_dwordx4 v[248:251], v5, s[44:47], s7 offen offset:1536
    v_mfma_f32_16x16x32_bf16 a[36:39], v[72:75], a[148:151], a[36:39]
    v_perm_b32 v68, v164, v160, s5
    v_perm_b32 v69, v172, v168, s5
    v_mfma_f32_16x16x32_bf16 a[40:43], v[72:75], a[152:155], a[40:43]
    v_perm_b32 v70, v180, v176, s5
    v_mfma_f32_16x16x32_bf16 a[44:47], v[72:75], a[156:159], a[44:47]
    buffer_load_dwordx4 v[252:255], v5, s[44:47], s7 offen offset:1792
    v_mfma_f32_16x16x32_bf16 a[60:63], v[76:79], a[156:159], a[60:63]
    v_perm_b32 v71, v188, v184, s5
    v_perm_b32 v72, v165, v161, s4
    v_mfma_f32_16x16x32_bf16 a[56:59], v[76:79], a[152:155], a[56:59]
    v_perm_b32 v73, v173, v169, s4
    v_mfma_f32_16x16x32_bf16 a[52:55], v[76:79], a[148:151], a[52:55]
    ds_read_b128 a[136:139], v26
    v_perm_b32 v74, v181, v177, s4
    v_mfma_f32_16x16x32_bf16 a[48:51], v[76:79], a[144:147], a[48:51]
    v_perm_b32 v75, v189, v185, s4
    v_mfma_f32_16x16x32_bf16 a[64:67], v[80:83], a[144:147], a[64:67]
    v_perm_b32 v76, v165, v161, s5
    v_mfma_f32_16x16x32_bf16 a[68:71], v[80:83], a[148:151], a[68:71]
    v_perm_b32 v77, v173, v169, s5
    v_mfma_f32_16x16x32_bf16 a[72:75], v[80:83], a[152:155], a[72:75]
    v_perm_b32 v78, v181, v177, s5
    v_mfma_f32_16x16x32_bf16 a[76:79], v[80:83], a[156:159], a[76:79]
    v_perm_b32 v79, v189, v185, s5
    v_mfma_f32_16x16x32_bf16 a[92:95], v[84:87], a[156:159], a[92:95]
    ds_read_b128 a[140:143], v30
    v_perm_b32 v80, v166, v162, s4
    v_mfma_f32_16x16x32_bf16 a[88:91], v[84:87], a[152:155], a[88:91]
    v_perm_b32 v81, v174, v170, s4
    v_mfma_f32_16x16x32_bf16 a[84:87], v[84:87], a[148:151], a[84:87]
    v_perm_b32 v82, v182, v178, s4
    v_mfma_f32_16x16x32_bf16 a[80:83], v[84:87], a[144:147], a[80:83]
    v_perm_b32 v83, v190, v186, s4
    v_mfma_f32_16x16x32_bf16 a[96:99], v[88:91], a[144:147], a[96:99]
    v_perm_b32 v84, v166, v162, s5
    v_mfma_f32_16x16x32_bf16 a[100:103], v[88:91], a[148:151], a[100:103]
    v_perm_b32 v85, v174, v170, s5
    v_mfma_f32_16x16x32_bf16 a[104:107], v[88:91], a[152:155], a[104:107]
    v_perm_b32 v86, v182, v178, s5
    v_mfma_f32_16x16x32_bf16 a[108:111], v[88:91], a[156:159], a[108:111]
    v_perm_b32 v87, v190, v186, s5
    v_mfma_f32_16x16x32_bf16 a[124:127], v[92:95], a[156:159], a[124:127]
    v_perm_b32 v88, v167, v163, s4
    v_mfma_f32_16x16x32_bf16 a[120:123], v[92:95], a[152:155], a[120:123]
    v_perm_b32 v89, v175, v171, s4
    v_mfma_f32_16x16x32_bf16 a[116:119], v[92:95], a[148:151], a[116:119]
    v_perm_b32 v90, v183, v179, s4
    v_mfma_f32_16x16x32_bf16 a[112:115], v[92:95], a[144:147], a[112:115]
    v_perm_b32 v91, v191, v187, s4
    s_waitcnt lgkmcnt(3)
    v_mfma_f32_16x16x32_bf16 a[0:3], v[64:67], a[128:131], a[0:3]
    v_perm_b32 v92, v167, v163, s5
    s_waitcnt lgkmcnt(2)
    v_mfma_f32_16x16x32_bf16 a[4:7], v[64:67], a[132:135], a[4:7]
    v_perm_b32 v93, v175, v171, s5
    s_waitcnt lgkmcnt(1)
    v_mfma_f32_16x16x32_bf16 a[8:11], v[64:67], a[136:139], a[8:11]
    ds_read_b128 a[164:167], v23
    v_perm_b32 v94, v183, v179, s5
    s_waitcnt lgkmcnt(1)
    v_mfma_f32_16x16x32_bf16 a[12:15], v[64:67], a[140:143], a[12:15]
    v_perm_b32 v95, v191, v187, s5
    s_waitcnt vmcnt(8)
    v_mfma_f32_16x16x32_bf16 a[28:31], v[68:71], a[140:143], a[28:31]
    v_perm_b32 v64, v196, v192, s4
    v_mfma_f32_16x16x32_bf16 a[24:27], v[68:71], a[136:139], a[24:27]
    v_perm_b32 v65, v204, v200, s4
    v_mfma_f32_16x16x32_bf16 a[20:23], v[68:71], a[132:135], a[20:23]
    v_perm_b32 v66, v212, v208, s4
    v_mfma_f32_16x16x32_bf16 a[16:19], v[68:71], a[128:131], a[16:19]
    ds_read_b128 a[180:183], v37
    v_perm_b32 v67, v220, v216, s4
    v_mfma_f32_16x16x32_bf16 a[32:35], v[72:75], a[128:131], a[32:35]
    v_perm_b32 v68, v196, v192, s5
    v_mfma_f32_16x16x32_bf16 a[36:39], v[72:75], a[132:135], a[36:39]
    v_perm_b32 v69, v204, v200, s5
    v_mfma_f32_16x16x32_bf16 a[40:43], v[72:75], a[136:139], a[40:43]
    v_perm_b32 v70, v212, v208, s5
    v_mfma_f32_16x16x32_bf16 a[44:47], v[72:75], a[140:143], a[44:47]
    v_perm_b32 v71, v220, v216, s5
    v_mfma_f32_16x16x32_bf16 a[60:63], v[76:79], a[140:143], a[60:63]
    ds_read_b128 a[168:171], v27
    v_perm_b32 v72, v197, v193, s4
    v_mfma_f32_16x16x32_bf16 a[56:59], v[76:79], a[136:139], a[56:59]
    v_perm_b32 v73, v205, v201, s4
    v_mfma_f32_16x16x32_bf16 a[52:55], v[76:79], a[132:135], a[52:55]
    v_perm_b32 v74, v213, v209, s4
    v_mfma_f32_16x16x32_bf16 a[48:51], v[76:79], a[128:131], a[48:51]
    v_perm_b32 v75, v221, v217, s4
    v_mfma_f32_16x16x32_bf16 a[64:67], v[80:83], a[128:131], a[64:67]
    v_perm_b32 v76, v197, v193, s5
    v_mfma_f32_16x16x32_bf16 a[68:71], v[80:83], a[132:135], a[68:71]
    ds_read_b128 a[184:187], v38
    v_perm_b32 v77, v205, v201, s5
    v_mfma_f32_16x16x32_bf16 a[72:75], v[80:83], a[136:139], a[72:75]
    v_perm_b32 v78, v213, v209, s5
    v_mfma_f32_16x16x32_bf16 a[76:79], v[80:83], a[140:143], a[76:79]
    v_perm_b32 v79, v221, v217, s5
    v_mfma_f32_16x16x32_bf16 a[92:95], v[84:87], a[140:143], a[92:95]
    v_perm_b32 v80, v198, v194, s4
    v_mfma_f32_16x16x32_bf16 a[88:91], v[84:87], a[136:139], a[88:91]
    v_perm_b32 v81, v206, v202, s4
    v_mfma_f32_16x16x32_bf16 a[84:87], v[84:87], a[132:135], a[84:87]
    ds_read_b128 a[172:175], v31
    v_perm_b32 v82, v214, v210, s4
    v_mfma_f32_16x16x32_bf16 a[80:83], v[84:87], a[128:131], a[80:83]
    v_perm_b32 v83, v222, v218, s4
    v_mfma_f32_16x16x32_bf16 a[96:99], v[88:91], a[128:131], a[96:99]
    v_perm_b32 v84, v198, v194, s5
    s_waitcnt vmcnt(0)
    v_perm_b32 v96, v228, v224, s4
    v_mfma_f32_16x16x32_bf16 a[100:103], v[88:91], a[132:135], a[100:103]
    v_perm_b32 v85, v206, v202, s5
    v_perm_b32 v97, v236, v232, s4
    v_mfma_f32_16x16x32_bf16 a[104:107], v[88:91], a[136:139], a[104:107]
    v_perm_b32 v86, v214, v210, s5
    v_perm_b32 v98, v244, v240, s4
    v_mfma_f32_16x16x32_bf16 a[108:111], v[88:91], a[140:143], a[108:111]
    ds_read_b128 a[188:191], v39
    v_perm_b32 v87, v222, v218, s5
    v_perm_b32 v99, v252, v248, s4
    v_mfma_f32_16x16x32_bf16 a[124:127], v[92:95], a[140:143], a[124:127]
    v_perm_b32 v88, v199, v195, s4
    v_perm_b32 v100, v228, v224, s5
    v_mfma_f32_16x16x32_bf16 a[120:123], v[92:95], a[136:139], a[120:123]
    v_perm_b32 v89, v207, v203, s4
    v_perm_b32 v101, v236, v232, s5
    v_mfma_f32_16x16x32_bf16 a[116:119], v[92:95], a[132:135], a[116:119]
    v_perm_b32 v90, v215, v211, s4
    v_perm_b32 v102, v244, v240, s5
    v_mfma_f32_16x16x32_bf16 a[112:115], v[92:95], a[128:131], a[112:115]
    v_perm_b32 v91, v223, v219, s4
    v_perm_b32 v103, v252, v248, s5
    s_waitcnt lgkmcnt(5)
    v_mfma_f32_16x16x32_bf16 a[4:7], v[64:67], a[164:167], a[4:7]
    ds_read_b128 a[160:163], v19
    v_perm_b32 v92, v199, v195, s5
    v_perm_b32 v104, v229, v225, s4
    v_mfma_f32_16x16x32_bf16 a[20:23], v[68:71], a[164:167], a[20:23]
    v_perm_b32 v93, v207, v203, s5
    v_perm_b32 v105, v237, v233, s4
    v_mfma_f32_16x16x32_bf16 a[36:39], v[72:75], a[164:167], a[36:39]
    v_perm_b32 v94, v215, v211, s5
    v_perm_b32 v106, v245, v241, s4
    v_mfma_f32_16x16x32_bf16 a[52:55], v[76:79], a[164:167], a[52:55]
    v_perm_b32 v95, v223, v219, s5
    v_perm_b32 v107, v253, v249, s4
    v_mfma_f32_16x16x32_bf16 a[68:71], v[80:83], a[164:167], a[68:71]
    v_perm_b32 v108, v229, v225, s5
    v_perm_b32 v109, v237, v233, s5
    v_mfma_f32_16x16x32_bf16 a[84:87], v[84:87], a[164:167], a[84:87]
    ds_read_b128 a[176:179], v36
    v_perm_b32 v110, v245, v241, s5
    v_perm_b32 v111, v253, v249, s5
    v_mfma_f32_16x16x32_bf16 a[100:103], v[88:91], a[164:167], a[100:103]
    v_perm_b32 v112, v230, v226, s4
    v_perm_b32 v113, v238, v234, s4
    v_mfma_f32_16x16x32_bf16 a[116:119], v[92:95], a[164:167], a[116:119]
    v_perm_b32 v114, v246, v242, s4
    v_perm_b32 v115, v254, v250, s4
    s_waitcnt lgkmcnt(6)
    v_mfma_f32_16x16x32_bf16 a[4:7], v[96:99], a[180:183], a[4:7]
    v_perm_b32 v116, v230, v226, s5
    v_perm_b32 v117, v238, v234, s5
    v_mfma_f32_16x16x32_bf16 a[20:23], v[100:103], a[180:183], a[20:23]
    v_perm_b32 v118, v246, v242, s5
    v_perm_b32 v119, v254, v250, s5
    v_mfma_f32_16x16x32_bf16 a[36:39], v[104:107], a[180:183], a[36:39]
    v_perm_b32 v120, v231, v227, s4
    v_perm_b32 v121, v239, v235, s4
    v_mfma_f32_16x16x32_bf16 a[52:55], v[108:111], a[180:183], a[52:55]
    v_perm_b32 v122, v247, v243, s4
    v_perm_b32 v123, v255, v251, s4
    v_mfma_f32_16x16x32_bf16 a[68:71], v[112:115], a[180:183], a[68:71]
    v_perm_b32 v124, v231, v227, s5
    v_perm_b32 v125, v239, v235, s5
    v_mfma_f32_16x16x32_bf16 a[84:87], v[116:119], a[180:183], a[84:87]
    v_perm_b32 v126, v247, v243, s5
    v_perm_b32 v127, v255, v251, s5
    v_mfma_f32_16x16x32_bf16 a[100:103], v[120:123], a[180:183], a[100:103]
    v_lshlrev_b32 v13, 6, v4
    v_add_u32 v13, 162432, v13
    s_lshl_b32 s10, s3, 6
    s_add_u32 s10, s10, 162944
    v_lshl_add_u32 v14, v3, 2, s10
    v_mfma_f32_16x16x32_bf16 a[116:119], v[124:127], a[180:183], a[116:119]
    ds_read_b128 v[160:163], v13 offset:0
    s_waitcnt lgkmcnt(6)
    v_mfma_f32_16x16x32_bf16 a[8:11], v[64:67], a[168:171], a[8:11]
    ds_read_b128 v[164:167], v13 offset:16
    v_mfma_f32_16x16x32_bf16 a[24:27], v[68:71], a[168:171], a[24:27]
    ds_read_b128 v[168:171], v13 offset:32
    v_mfma_f32_16x16x32_bf16 a[40:43], v[72:75], a[168:171], a[40:43]
    ds_write_b128 v44, a[4:7] offset:0
    ds_read_b128 v[172:175], v13 offset:48
    v_mfma_f32_16x16x32_bf16 a[56:59], v[76:79], a[168:171], a[56:59]
    v_mfma_f32_16x16x32_bf16 a[72:75], v[80:83], a[168:171], a[72:75]
    ds_read_b128 v[176:179], v13 offset:256
    v_mfma_f32_16x16x32_bf16 a[88:91], v[84:87], a[168:171], a[88:91]
    ds_write_b128 v44, a[20:23] offset:1024
    v_mfma_f32_16x16x32_bf16 a[104:107], v[88:91], a[168:171], a[104:107]
    v_mfma_f32_16x16x32_bf16 a[120:123], v[92:95], a[168:171], a[120:123]
    ds_read_b128 v[180:183], v13 offset:272
    s_waitcnt lgkmcnt(12)
    v_mfma_f32_16x16x32_bf16 a[8:11], v[96:99], a[184:187], a[8:11]
    ds_write_b128 v44, a[36:39] offset:2048
    v_mfma_f32_16x16x32_bf16 a[24:27], v[100:103], a[184:187], a[24:27]
    s_waitcnt lgkmcnt(4)
    v_lshlrev_b32 v192, 16, v160
    v_and_b32 v193, 0xffff0000, v160
    v_mfma_f32_16x16x32_bf16 a[40:43], v[104:107], a[184:187], a[40:43]
    ds_read_b128 v[184:187], v13 offset:288
    v_lshlrev_b32 v194, 16, v161
    v_and_b32 v195, 0xffff0000, v161
    v_mfma_f32_16x16x32_bf16 a[56:59], v[108:111], a[184:187], a[56:59]
    ds_write_b128 v44, a[52:55] offset:3072
    v_lshlrev_b32 v196, 16, v162
    v_and_b32 v197, 0xffff0000, v162
    v_mfma_f32_16x16x32_bf16 a[72:75], v[112:115], a[184:187], a[72:75]
    v_lshlrev_b32 v198, 16, v163
    v_and_b32 v199, 0xffff0000, v163
    v_mfma_f32_16x16x32_bf16 a[88:91], v[116:119], a[184:187], a[88:91]
    ds_read_b128 v[188:191], v13 offset:304
    v_lshlrev_b32 v200, 16, v164
    v_and_b32 v201, 0xffff0000, v164
    v_mfma_f32_16x16x32_bf16 a[104:107], v[120:123], a[184:187], a[104:107]
    ds_write_b128 v44, a[68:71] offset:4096
    v_lshlrev_b32 v202, 16, v165
    v_and_b32 v203, 0xffff0000, v165
    v_mfma_f32_16x16x32_bf16 a[120:123], v[124:127], a[184:187], a[120:123]
    v_lshlrev_b32 v204, 16, v166
    v_and_b32 v205, 0xffff0000, v166
    v_mfma_f32_16x16x32_bf16 a[12:15], v[64:67], a[172:175], a[12:15]
    ds_read_b32 v57, v14
    v_lshlrev_b32 v206, 16, v167
    v_and_b32 v207, 0xffff0000, v167
    v_mfma_f32_16x16x32_bf16 a[28:31], v[68:71], a[172:175], a[28:31]
    ds_write_b128 v44, a[84:87] offset:5120
    v_lshlrev_b32 v208, 16, v168
    v_and_b32 v209, 0xffff0000, v168
    v_mfma_f32_16x16x32_bf16 a[44:47], v[72:75], a[172:175], a[44:47]
    v_lshlrev_b32 v210, 16, v169
    v_and_b32 v211, 0xffff0000, v169
    v_mfma_f32_16x16x32_bf16 a[60:63], v[76:79], a[172:175], a[60:63]
    v_lshlrev_b32 v212, 16, v170
    v_and_b32 v213, 0xffff0000, v170
    v_mfma_f32_16x16x32_bf16 a[76:79], v[80:83], a[172:175], a[76:79]
    ds_write_b128 v44, a[100:103] offset:6144
    v_lshlrev_b32 v214, 16, v171
    v_and_b32 v215, 0xffff0000, v171
    v_mfma_f32_16x16x32_bf16 a[92:95], v[84:87], a[172:175], a[92:95]
    v_lshlrev_b32 v216, 16, v172
    v_and_b32 v217, 0xffff0000, v172
    v_mfma_f32_16x16x32_bf16 a[108:111], v[88:91], a[172:175], a[108:111]
    v_lshlrev_b32 v218, 16, v173
    v_and_b32 v219, 0xffff0000, v173
    v_mfma_f32_16x16x32_bf16 a[124:127], v[92:95], a[172:175], a[124:127]
    ds_write_b128 v44, a[116:119] offset:7168
    v_lshlrev_b32 v220, 16, v174
    v_and_b32 v221, 0xffff0000, v174
    v_mfma_f32_16x16x32_bf16 a[12:15], v[96:99], a[188:191], a[12:15]
    v_lshlrev_b32 v222, 16, v175
    v_and_b32 v223, 0xffff0000, v175
    v_mfma_f32_16x16x32_bf16 a[28:31], v[100:103], a[188:191], a[28:31]
    v_mfma_f32_16x16x32_bf16 a[44:47], v[104:107], a[188:191], a[44:47]
    ds_write_b128 v44, a[8:11] offset:8192
    v_mfma_f32_16x16x32_bf16 a[60:63], v[108:111], a[188:191], a[60:63]
    v_mfma_f32_16x16x32_bf16 a[76:79], v[112:115], a[188:191], a[76:79]
    v_mfma_f32_16x16x32_bf16 a[92:95], v[116:119], a[188:191], a[92:95]
    ds_write_b128 v44, a[24:27] offset:9216
    v_mfma_f32_16x16x32_bf16 a[108:111], v[120:123], a[188:191], a[108:111]
    v_mfma_f32_16x16x32_bf16 a[124:127], v[124:127], a[188:191], a[124:127]
    v_mfma_f32_16x16x32_bf16 a[0:3], v[64:67], a[160:163], a[0:3]
    ds_write_b128 v44, a[40:43] offset:10240
    v_mfma_f32_16x16x32_bf16 a[16:19], v[68:71], a[160:163], a[16:19]
    v_mfma_f32_16x16x32_bf16 a[32:35], v[72:75], a[160:163], a[32:35]
    v_mfma_f32_16x16x32_bf16 a[48:51], v[76:79], a[160:163], a[48:51]
    ds_write_b128 v44, a[56:59] offset:11264
    v_mfma_f32_16x16x32_bf16 a[64:67], v[80:83], a[160:163], a[64:67]
    v_mfma_f32_16x16x32_bf16 a[80:83], v[84:87], a[160:163], a[80:83]
    v_mfma_f32_16x16x32_bf16 a[96:99], v[88:91], a[160:163], a[96:99]
    ds_write_b128 v44, a[72:75] offset:12288
    v_mfma_f32_16x16x32_bf16 a[112:115], v[92:95], a[160:163], a[112:115]
    v_mfma_f32_16x16x32_bf16 a[0:3], v[96:99], a[176:179], a[0:3]
    v_mfma_f32_16x16x32_bf16 a[16:19], v[100:103], a[176:179], a[16:19]
    ds_write_b128 v44, a[88:91] offset:13312
    v_mfma_f32_16x16x32_bf16 a[32:35], v[104:107], a[176:179], a[32:35]
    v_mfma_f32_16x16x32_bf16 a[48:51], v[108:111], a[176:179], a[48:51]
    v_mfma_f32_16x16x32_bf16 a[64:67], v[112:115], a[176:179], a[64:67]
    ds_write_b128 v44, a[104:107] offset:14336
    v_mfma_f32_16x16x32_bf16 a[80:83], v[116:119], a[176:179], a[80:83]
    v_mfma_f32_16x16x32_bf16 a[96:99], v[120:123], a[176:179], a[96:99]
    v_mfma_f32_16x16x32_bf16 a[112:115], v[124:127], a[176:179], a[112:115]
    ds_write_b128 v44, a[120:123] offset:15360
    s_nop 1
    ds_write_b128 v44, a[12:15] offset:16384
    v_accvgpr_read_b32 v64, a0
    v_accvgpr_read_b32 v65, a1
    v_accvgpr_read_b32 v66, a2
    v_accvgpr_read_b32 v67, a3
    ds_write_b128 v44, a[28:31] offset:17408
    v_accvgpr_read_b32 v68, a16
    v_accvgpr_read_b32 v69, a17
    v_accvgpr_read_b32 v70, a18
    v_accvgpr_read_b32 v71, a19
    ds_write_b128 v44, a[44:47] offset:18432
    v_accvgpr_read_b32 v72, a32
    v_accvgpr_read_b32 v73, a33
    v_accvgpr_read_b32 v74, a34
    v_accvgpr_read_b32 v75, a35
    ds_write_b128 v44, a[60:63] offset:19456
    v_accvgpr_read_b32 v76, a48
    v_accvgpr_read_b32 v77, a49
    v_accvgpr_read_b32 v78, a50
    v_accvgpr_read_b32 v79, a51
    ds_write_b128 v44, a[76:79] offset:20480
    v_accvgpr_read_b32 v80, a64
    v_accvgpr_read_b32 v81, a65
    v_accvgpr_read_b32 v82, a66
    v_accvgpr_read_b32 v83, a67
    ds_write_b128 v44, a[92:95] offset:21504
    v_accvgpr_read_b32 v84, a80
    v_accvgpr_read_b32 v85, a81
    v_accvgpr_read_b32 v86, a82
    v_accvgpr_read_b32 v87, a83
    ds_write_b128 v44, a[108:111] offset:22528
    v_accvgpr_read_b32 v88, a96
    v_accvgpr_read_b32 v89, a97
    v_accvgpr_read_b32 v90, a98
    v_accvgpr_read_b32 v91, a99
    ds_write_b128 v44, a[124:127] offset:23552
    v_accvgpr_read_b32 v92, a112
    v_accvgpr_read_b32 v93, a113
    v_accvgpr_read_b32 v94, a114
    v_accvgpr_read_b32 v95, a115
    s_waitcnt lgkmcnt(0)
    s_barrier
    ds_read_b128 v[96:99], v45 offset:0
    ds_read_b128 v[128:131], v46 offset:8192
    ds_read_b128 v[224:227], v47 offset:16384
    ds_read_b128 v[100:103], v45 offset:1024
    ds_read_b128 v[132:135], v46 offset:9216
    ds_read_b128 v[228:231], v47 offset:17408
    ds_read_b128 v[104:107], v45 offset:2048
    ds_read_b128 v[136:139], v46 offset:10240
    ds_read_b128 v[232:235], v47 offset:18432
    ds_read_b128 v[108:111], v45 offset:3072
    ds_read_b128 v[140:143], v46 offset:11264
    ds_read_b128 v[236:239], v47 offset:19456
    ds_read_b128 v[112:115], v45 offset:4096
    ds_read_b128 v[144:147], v46 offset:12288
    v_mov_b32 v32, 0
    v_mov_b32 v33, 0
    v_mov_b32 v34, 0
    v_mov_b32 v35, 0
    s_waitcnt lgkmcnt(13)
    ds_read_b128 v[240:243], v47 offset:20480
    v_pk_add_f32 v[64:65], v[64:65], v[96:97]
    v_pk_add_f32 v[66:67], v[66:67], v[98:99]
    s_waitcnt lgkmcnt(13)
    ds_read_b128 v[116:119], v45 offset:5120
    v_pk_add_f32 v[64:65], v[64:65], v[128:129]
    v_pk_add_f32 v[66:67], v[66:67], v[130:131]
    s_waitcnt lgkmcnt(13)
    ds_read_b128 v[148:151], v46 offset:13312
    v_pk_add_f32 v[64:65], v[64:65], v[224:225]
    v_pk_add_f32 v[66:67], v[66:67], v[226:227]
    s_waitcnt lgkmcnt(13)
    ds_read_b128 v[244:247], v47 offset:21504
    v_pk_add_f32 v[68:69], v[68:69], v[100:101]
    v_pk_add_f32 v[70:71], v[70:71], v[102:103]
    s_waitcnt lgkmcnt(13)
    ds_read_b128 v[120:123], v45 offset:6144
    v_pk_add_f32 v[68:69], v[68:69], v[132:133]
    v_pk_add_f32 v[70:71], v[70:71], v[134:135]
    s_waitcnt lgkmcnt(13)
    ds_read_b128 v[152:155], v46 offset:14336
    v_pk_add_f32 v[68:69], v[68:69], v[228:229]
    v_pk_add_f32 v[70:71], v[70:71], v[230:231]
    v_cvt_pk_bf16_f32 v16, v64, v68
    v_cvt_pk_bf16_f32 v20, v65, v69
    v_cvt_pk_bf16_f32 v24, v66, v70
    v_cvt_pk_bf16_f32 v28, v67, v71
    v_lshlrev_b32 v18, 16, v16
    v_and_b32 v19, 0xffff0000, v16
    v_lshlrev_b32 v22, 16, v20
    v_and_b32 v23, 0xffff0000, v20
    v_lshlrev_b32 v26, 16, v24
    v_and_b32 v27, 0xffff0000, v24
    v_lshlrev_b32 v30, 16, v28
    v_and_b32 v31, 0xffff0000, v28
    v_pk_add_f32 v[18:19], v[18:19], v[192:193]
    v_pk_add_f32 v[22:23], v[22:23], v[200:201]
    v_pk_add_f32 v[26:27], v[26:27], v[208:209]
    v_pk_add_f32 v[30:31], v[30:31], v[216:217]
    v_cvt_pk_bf16_f32 v16, v18, v19
    v_cvt_pk_bf16_f32 v20, v22, v23
    v_cvt_pk_bf16_f32 v24, v26, v27
    v_cvt_pk_bf16_f32 v28, v30, v31
    v_pk_max_i16 v16, v16, 0
    v_pk_max_i16 v20, v20, 0
    v_pk_max_i16 v24, v24, 0
    v_pk_max_i16 v28, v28, 0
    v_dot2_f32_bf16 v32, v16, v176, v32
    v_dot2_f32_bf16 v33, v20, v180, v33
    v_dot2_f32_bf16 v34, v24, v184, v34
    v_dot2_f32_bf16 v35, v28, v188, v35
    s_waitcnt lgkmcnt(13)
    ds_read_b128 v[248:251], v47 offset:22528
    v_pk_add_f32 v[72:73], v[72:73], v[104:105]
    v_pk_add_f32 v[74:75], v[74:75], v[106:107]
    s_waitcnt lgkmcnt(13)
    ds_read_b128 v[124:127], v45 offset:7168
    v_pk_add_f32 v[72:73], v[72:73], v[136:137]
    v_pk_add_f32 v[74:75], v[74:75], v[138:139]
    s_waitcnt lgkmcnt(13)
    ds_read_b128 v[156:159], v46 offset:15360
    v_pk_add_f32 v[72:73], v[72:73], v[232:233]
    v_pk_add_f32 v[74:75], v[74:75], v[234:235]
    s_waitcnt lgkmcnt(13)
    ds_read_b128 v[252:255], v47 offset:23552
    v_pk_add_f32 v[76:77], v[76:77], v[108:109]
    v_pk_add_f32 v[78:79], v[78:79], v[110:111]
    s_waitcnt lgkmcnt(13)
    v_pk_add_f32 v[76:77], v[76:77], v[140:141]
    v_pk_add_f32 v[78:79], v[78:79], v[142:143]
    s_waitcnt lgkmcnt(12)
    v_pk_add_f32 v[76:77], v[76:77], v[236:237]
    v_pk_add_f32 v[78:79], v[78:79], v[238:239]
    v_cvt_pk_bf16_f32 v16, v72, v76
    v_cvt_pk_bf16_f32 v20, v73, v77
    v_cvt_pk_bf16_f32 v24, v74, v78
    v_cvt_pk_bf16_f32 v28, v75, v79
    v_lshlrev_b32 v18, 16, v16
    v_and_b32 v19, 0xffff0000, v16
    v_lshlrev_b32 v22, 16, v20
    v_and_b32 v23, 0xffff0000, v20
    v_lshlrev_b32 v26, 16, v24
    v_and_b32 v27, 0xffff0000, v24
    v_lshlrev_b32 v30, 16, v28
    v_and_b32 v31, 0xffff0000, v28
    v_pk_add_f32 v[18:19], v[18:19], v[194:195]
    v_pk_add_f32 v[22:23], v[22:23], v[202:203]
    v_pk_add_f32 v[26:27], v[26:27], v[210:211]
    v_pk_add_f32 v[30:31], v[30:31], v[218:219]
    v_cvt_pk_bf16_f32 v16, v18, v19
    v_cvt_pk_bf16_f32 v20, v22, v23
    v_cvt_pk_bf16_f32 v24, v26, v27
    v_cvt_pk_bf16_f32 v28, v30, v31
    v_pk_max_i16 v16, v16, 0
    v_pk_max_i16 v20, v20, 0
    v_pk_max_i16 v24, v24, 0
    v_pk_max_i16 v28, v28, 0
    v_dot2_f32_bf16 v32, v16, v177, v32
    v_dot2_f32_bf16 v33, v20, v181, v33
    v_dot2_f32_bf16 v34, v24, v185, v34
    v_dot2_f32_bf16 v35, v28, v189, v35
    s_waitcnt lgkmcnt(11)
    v_pk_add_f32 v[80:81], v[80:81], v[112:113]
    v_pk_add_f32 v[82:83], v[82:83], v[114:115]
    s_waitcnt lgkmcnt(10)
    v_pk_add_f32 v[80:81], v[80:81], v[144:145]
    v_pk_add_f32 v[82:83], v[82:83], v[146:147]
    s_waitcnt lgkmcnt(9)
    v_pk_add_f32 v[80:81], v[80:81], v[240:241]
    v_pk_add_f32 v[82:83], v[82:83], v[242:243]
    s_waitcnt lgkmcnt(8)
    v_pk_add_f32 v[84:85], v[84:85], v[116:117]
    v_pk_add_f32 v[86:87], v[86:87], v[118:119]
    s_waitcnt lgkmcnt(7)
    v_pk_add_f32 v[84:85], v[84:85], v[148:149]
    v_pk_add_f32 v[86:87], v[86:87], v[150:151]
    s_waitcnt lgkmcnt(6)
    v_pk_add_f32 v[84:85], v[84:85], v[244:245]
    v_pk_add_f32 v[86:87], v[86:87], v[246:247]
    v_cvt_pk_bf16_f32 v16, v80, v84
    v_cvt_pk_bf16_f32 v20, v81, v85
    v_cvt_pk_bf16_f32 v24, v82, v86
    v_cvt_pk_bf16_f32 v28, v83, v87
    v_lshlrev_b32 v18, 16, v16
    v_and_b32 v19, 0xffff0000, v16
    v_lshlrev_b32 v22, 16, v20
    v_and_b32 v23, 0xffff0000, v20
    v_lshlrev_b32 v26, 16, v24
    v_and_b32 v27, 0xffff0000, v24
    v_lshlrev_b32 v30, 16, v28
    v_and_b32 v31, 0xffff0000, v28
    v_pk_add_f32 v[18:19], v[18:19], v[196:197]
    v_pk_add_f32 v[22:23], v[22:23], v[204:205]
    v_pk_add_f32 v[26:27], v[26:27], v[212:213]
    v_pk_add_f32 v[30:31], v[30:31], v[220:221]
    v_cvt_pk_bf16_f32 v16, v18, v19
    v_cvt_pk_bf16_f32 v20, v22, v23
    v_cvt_pk_bf16_f32 v24, v26, v27
    v_cvt_pk_bf16_f32 v28, v30, v31
    v_pk_max_i16 v16, v16, 0
    v_pk_max_i16 v20, v20, 0
    v_pk_max_i16 v24, v24, 0
    v_pk_max_i16 v28, v28, 0
    v_dot2_f32_bf16 v32, v16, v178, v32
    v_dot2_f32_bf16 v33, v20, v182, v33
    v_dot2_f32_bf16 v34, v24, v186, v34
    v_dot2_f32_bf16 v35, v28, v190, v35
    s_waitcnt lgkmcnt(5)
    v_pk_add_f32 v[88:89], v[88:89], v[120:121]
    v_pk_add_f32 v[90:91], v[90:91], v[122:123]
    s_waitcnt lgkmcnt(4)
    v_pk_add_f32 v[88:89], v[88:89], v[152:153]
    v_pk_add_f32 v[90:91], v[90:91], v[154:155]
    s_waitcnt lgkmcnt(3)
    v_pk_add_f32 v[88:89], v[88:89], v[248:249]
    v_pk_add_f32 v[90:91], v[90:91], v[250:251]
    s_waitcnt lgkmcnt(2)
    v_pk_add_f32 v[92:93], v[92:93], v[124:125]
    v_pk_add_f32 v[94:95], v[94:95], v[126:127]
    s_waitcnt lgkmcnt(1)
    v_pk_add_f32 v[92:93], v[92:93], v[156:157]
    v_pk_add_f32 v[94:95], v[94:95], v[158:159]
    s_waitcnt lgkmcnt(0)
    v_pk_add_f32 v[92:93], v[92:93], v[252:253]
    v_pk_add_f32 v[94:95], v[94:95], v[254:255]
    v_cvt_pk_bf16_f32 v16, v88, v92
    v_cvt_pk_bf16_f32 v20, v89, v93
    v_cvt_pk_bf16_f32 v24, v90, v94
    v_cvt_pk_bf16_f32 v28, v91, v95
    v_lshlrev_b32 v18, 16, v16
    v_and_b32 v19, 0xffff0000, v16
    v_lshlrev_b32 v22, 16, v20
    v_and_b32 v23, 0xffff0000, v20
    v_lshlrev_b32 v26, 16, v24
    v_and_b32 v27, 0xffff0000, v24
    v_lshlrev_b32 v30, 16, v28
    v_and_b32 v31, 0xffff0000, v28
    v_pk_add_f32 v[18:19], v[18:19], v[198:199]
    v_pk_add_f32 v[22:23], v[22:23], v[206:207]
    v_pk_add_f32 v[26:27], v[26:27], v[214:215]
    v_pk_add_f32 v[30:31], v[30:31], v[222:223]
    v_cvt_pk_bf16_f32 v16, v18, v19
    v_cvt_pk_bf16_f32 v20, v22, v23
    v_cvt_pk_bf16_f32 v24, v26, v27
    v_cvt_pk_bf16_f32 v28, v30, v31
    v_pk_max_i16 v16, v16, 0
    v_pk_max_i16 v20, v20, 0
    v_pk_max_i16 v24, v24, 0
    v_pk_max_i16 v28, v28, 0
    v_dot2_f32_bf16 v32, v16, v179, v32
    v_dot2_f32_bf16 v33, v20, v183, v33
    v_dot2_f32_bf16 v34, v24, v187, v34
    v_dot2_f32_bf16 v35, v28, v191, v35
    s_nop 2
    v_add_f32 v32, v32, v33
    v_add_f32 v34, v34, v35
    v_add_f32 v58, v32, v34
    v_mov_b32 v16, v58
    s_nop 1
    v_permlane32_swap_b32 v58, v16
    s_nop 1
    v_add_f32 v58, v58, v16
    v_mov_b32 v16, v58
    s_nop 1
    v_permlane16_swap_b32 v58, v16
    s_nop 1
    v_add_f32 v58, v58, v16
    v_cvt_pk_bf16_f32 v58, v58, v58
    v_lshlrev_b32 v58, 16, v58
    s_lshl_b32 s12, s81, 16
    v_add_f32 v58, s12, v58
    v_cvt_pk_bf16_f32 v58, v58, v58
    v_lshlrev_b32 v58, 16, v58
    v_add_f32 v58, v57, v58
    v_cvt_pk_bf16_f32 v58, v58, v58
    v_lshlrev_b32 v58, 16, v58
    v_mul_f32 v58, 0xbfb8aa3b, v58
    v_exp_f32 v58, v58
    s_nop 0
    v_add_f32 v58, 1.0, v58
    v_rcp_f32 v58, v58
    s_mov_b64 exec, 0xffff
    v_cvt_pk_bf16_f32 v58, v58, v58
    buffer_store_short v58, v63, s[60:63], 0 offen
L_end:
    s_endpgm
.section .rodata,"a"
.p2align 6
.amdhsa_kernel standalone__deep_cross_wide_deep__recsys_kernel
  .amdhsa_next_free_vgpr 512
  .amdhsa_next_free_sgpr 102
  .amdhsa_accum_offset 256
  .amdhsa_group_segment_fixed_size 0
  .amdhsa_kernarg_size 96
  .amdhsa_float_denorm_mode_32 3
  .amdhsa_user_sgpr_count 2
  .amdhsa_user_sgpr_kernarg_segment_ptr 1
  .amdhsa_system_sgpr_workgroup_id_x 1
.end_amdhsa_kernel
```
